```python
import torch

def _softmax(x, axis=-1):
    return torch.softmax(x, dim=axis)
def _gelu(x):
    return torch.nn.functional.gelu(x, approximate="tanh")
def _silu(x):
    return torch.nn.functional.silu(x)
def _sigmoid(x):
    return torch.sigmoid(x)
def _layernorm(x, axis=-1, eps=1e-5):
    m = x.mean(dim=axis, keepdim=True)
    v = x.var(dim=axis, keepdim=True, unbiased=False)
    return (x - m) / torch.sqrt(v + eps)
def _scatter_add(tgt, idx, src, axis=0):
    return tgt.clone().index_add_(axis, idx, src)
def _segment_sum(src, seg, n):
    out = torch.zeros((n,) + src.shape[1:], dtype=src.dtype)
    return out.index_add_(0, seg, src)
def _pad(x, pw):
    flat = tuple(v for pair in reversed(pw) for v in pair)
    return torch.nn.functional.pad(x, flat)

kernel_name = 'sequential_preLN__mha_block_cached__swiglu_ffn__decode'

def setup_inputs():

    _w = (lambda a: (lambda t: t.to(torch.bfloat16) if t.is_floating_point() else t)(torch.as_tensor(a)))
    def _A_setup():
        B, Sq, D = 1, 1, 512
        H, Sk, Dh = 32, 16384, 128
        return {
            "x": _w((lambda *s: torch.randn(*s, dtype=torch.bfloat16) * 0.05)(B, Sq, D)),
            "k_cache": _w((lambda *s: torch.randn(*s, dtype=torch.bfloat16) * 3.2)(B, H, Sk, Dh)),
            "v_cache": _w((lambda *s: torch.randn(*s, dtype=torch.bfloat16) * 0.4)(B, H, Sk, Dh)),
            "wq": _w((lambda *s: torch.randn(*s, dtype=torch.bfloat16) * 3.2)(D, H * Dh) * (D ** -0.5)),
            "wo": _w((lambda *s: torch.randn(*s, dtype=torch.bfloat16) * 0.4)(H * Dh, D) * ((H * Dh) ** -0.5)),
        }
    _A_in = _A_setup()

    def _B_setup():
        B, S, D, F = 1, 1, 512, 1792
        return {
            "x": _w((lambda *s: torch.randn(*s, dtype=torch.bfloat16) * 0.05)(B, S, D)),
            "w_gate": _w((lambda *s: torch.randn(*s, dtype=torch.bfloat16) * 0.05)(D, F)),
            "w_up": _w((lambda *s: torch.randn(*s, dtype=torch.bfloat16) * 0.05)(D, F)),
            "w_down": _w((lambda *s: torch.randn(*s, dtype=torch.bfloat16) * 0.05)(F, D)),
        }
    _B_in = _B_setup()

    return {
        "A_x": _A_in["x"],
        "A_k_cache": _A_in["k_cache"],
        "A_v_cache": _A_in["v_cache"],
        "A_wq": _A_in["wq"],
        "A_wo": _A_in["wo"],
        "B_x": _B_in["x"],
        "B_w_gate": _B_in["w_gate"],
        "B_w_up": _B_in["w_up"],
        "B_w_down": _B_in["w_down"],
    }

def reference(A_x, A_k_cache, A_v_cache, A_wq, A_wo, B_x, B_w_gate, B_w_up, B_w_down):
    def _A_ref(x, k_cache, v_cache, wq, wo):
        B, Sq, D = x.shape
        H, Dh = 32, 128
        q = (lambda x, *d: x.permute(*d))((x @ wq).reshape(B, Sq, H, Dh), 0, 2, 1, 3)
        scores = torch.einsum("bhqd,bhkd->bhqk", q, k_cache) * (Dh ** -0.5)
        p = _softmax(scores, axis=-1)
        o = torch.einsum("bhqk,bhkd->bhqd", p, v_cache)
        return (lambda x, *d: x.permute(*d))(o, 0, 2, 1, 3).reshape(B, Sq, H * Dh) @ wo

    def _B_ref(x, w_gate, w_up, w_down):
        g = _silu(x @ w_gate)
        u = x @ w_up
        return (g * u) @ w_down

    x = A_x
    h = x + _A_ref(_layernorm(x, axis=-1), A_k_cache, A_v_cache, A_wq, A_wo)
    h2 = h + _B_ref(_layernorm(h, axis=-1), B_w_gate, B_w_up, B_w_down)
    return h2
```

```asm
; @launch grid=(256,1,1) block=(512,1,1) lds=86016
.amdgcn_target "amdgcn-amd-amdhsa--gfx950"
.text
.globl sequential_preLN__mha_block_cached__swiglu_ffn__decode_kernel
.p2align 8
.type sequential_preLN__mha_block_cached__swiglu_ffn__decode_kernel,@function
sequential_preLN__mha_block_cached__swiglu_ffn__decode_kernel:
  s_load_dwordx16 s[16:31], s[0:1], 0
  s_load_dwordx8 s[32:39], s[0:1], 64
  s_cmp_ge_u32 s2, 256
  s_cbranch_scc1 L_end
  v_lshrrev_b32 v1, 6, v0
  v_and_b32 v0, 63, v0
  s_lshr_b32 s4, s2, 3
  v_readfirstlane_b32 s3, v1
  s_and_b32 s5, s2, 7
  v_lshrrev_b32 v3, 4, v0
  v_and_b32 v4, 15, v0
  s_cmp_lt_u32 s3, 4
  s_cbranch_scc1 L_S
  s_setprio 3
  v_lshlrev_b32 v5, 4, v0
  s_cmp_eq_u32 s3, 4
  s_cbranch_scc0 L_e6
  s_lshl_b32 s6, s5, 7
  v_lshl_add_u32 v6, v0, 1, s6
  s_lshl_b32 s6, s5, 19
  s_lshl_b32 s7, s4, 8
  s_add_u32 s6, s6, s7
  v_lshlrev_b32 v7, 17, v3
  v_lshl_add_u32 v7, v4, 4, v7
  s_mov_b32 s42, 0x400000
  s_mov_b32 s43, 0x20000
  v_mov_b32 v18, 0
  v_mov_b32 v19, 0
  v_mov_b32 v17, s7
  s_waitcnt lgkmcnt(0)
  s_mov_b32 s40, s22
  s_mov_b32 s41, s23
  s_load_dword s63, s[38:39], 16384
  global_load_dwordx4 v[8:11], v5, s[16:17]
  global_load_ushort v12, v6, s[16:17]
  buffer_load_dwordx4 v[64:67], v7, s[40:43], s6 offen
  s_add_u32 s6, s6, 8192
  buffer_load_dwordx4 v[68:71], v7, s[40:43], s6 offen
  s_add_u32 s6, s6, 8192
  buffer_load_dwordx4 v[72:75], v7, s[40:43], s6 offen
  s_add_u32 s6, s6, 8192
  buffer_load_dwordx4 v[76:79], v7, s[40:43], s6 offen
  s_add_u32 s6, s6, 8192
  buffer_load_dwordx4 v[80:83], v7, s[40:43], s6 offen
  s_add_u32 s6, s6, 8192
  buffer_load_dwordx4 v[84:87], v7, s[40:43], s6 offen
  s_add_u32 s6, s6, 8192
  buffer_load_dwordx4 v[88:91], v7, s[40:43], s6 offen
  s_add_u32 s6, s6, 8192
  buffer_load_dwordx4 v[92:95], v7, s[40:43], s6 offen
  s_add_u32 s6, s6, 8192
  buffer_load_dwordx4 v[96:99], v7, s[40:43], s6 offen
  s_add_u32 s6, s6, 8192
  buffer_load_dwordx4 v[100:103], v7, s[40:43], s6 offen
  s_add_u32 s6, s6, 8192
  buffer_load_dwordx4 v[104:107], v7, s[40:43], s6 offen
  s_add_u32 s6, s6, 8192
  buffer_load_dwordx4 v[108:111], v7, s[40:43], s6 offen
  s_add_u32 s6, s6, 8192
  buffer_load_dwordx4 v[112:115], v7, s[40:43], s6 offen
  s_add_u32 s6, s6, 8192
  buffer_load_dwordx4 v[116:119], v7, s[40:43], s6 offen
  s_add_u32 s6, s6, 8192
  buffer_load_dwordx4 v[120:123], v7, s[40:43], s6 offen
  s_add_u32 s6, s6, 8192
  buffer_load_dwordx4 v[124:127], v7, s[40:43], s6 offen
  s_cmp_lg_u32 s5, 0
  s_cbranch_scc1 L_nocnt
  s_mov_b64 exec, 1
  global_store_dword v17, v18, s[38:39] sc1
  s_mov_b64 exec, -1
L_nocnt:
  s_barrier
  s_branch L_T
L_e6:
  s_cmp_eq_u32 s3, 6
  s_cbranch_scc0 L_nocnt
  v_mov_b32 v28, -1
  v_mov_b32 v29, -1
  v_mov_b32 v30, -1
  v_mov_b32 v31, -1
  s_lshl_b32 s54, s4, 14
  s_lshl_b32 s6, s5, 8
  s_add_u32 s6, s6, s54
  s_add_u32 s6, s6, 524288
  v_add_u32 v13, s6, v5
  v_add_u32 v14, 0x2000, v13
  v_mov_b32 v15, 320
  ds_write_b32 v15, v28
  s_waitcnt lgkmcnt(0)
  s_mov_b64 exec, 0xffff
  global_store_dwordx4 v13, v[28:31], s[38:39] sc1
  global_store_dwordx4 v14, v[28:31], s[38:39] sc1
  s_mov_b64 exec, -1
  s_branch L_nocnt
L_S:
  v_bfe_u32 v5, v0, 2, 2
  v_and_b32 v6, 3, v0
  v_lshl_add_u32 v6, v3, 2, v6
  v_lshlrev_b32 v6, 4, v6
  v_lshl_add_u32 v1, v5, 8, v6
  s_lshl_b32 s6, s4, 22
  s_lshl_b32 s47, s5, 2
  s_add_u32 s47, s47, s3
  s_lshl_b32 s46, s47, 12
  s_add_u32 s48, s46, 1966080
  s_xor_b32 s49, s48, 2097152
  s_mov_b32 s10, 0x400000
  s_mov_b32 s11, 0x20000
  s_waitcnt lgkmcnt(0)
  s_add_u32 s8, s18, s6
  s_addc_u32 s9, s19, 0
  s_mov_b32 s42, s48
  buffer_load_dwordx4 v[64:67], v1, s[8:11], s48 offen offset:0 nt
  buffer_load_dwordx4 v[68:71], v1, s[8:11], s48 offen offset:1024 nt
  buffer_load_dwordx4 v[72:75], v1, s[8:11], s48 offen offset:2048 nt
  buffer_load_dwordx4 v[76:79], v1, s[8:11], s48 offen offset:3072 nt
  s_barrier
  buffer_load_dwordx4 v[80:83], v1, s[8:11], s49 offen offset:0 nt
  buffer_load_dwordx4 v[84:87], v1, s[8:11], s49 offen offset:1024 nt
  buffer_load_dwordx4 v[88:91], v1, s[8:11], s49 offen offset:2048 nt
  buffer_load_dwordx4 v[92:95], v1, s[8:11], s49 offen offset:3072 nt
  s_sub_u32 s48, s48, 131072
  s_and_b32 s48, s48, 2097151
  s_xor_b32 s49, s48, 2097152
  s_load_dword s60, s[38:39], 16384
  s_add_u32 s12, s20, s6
  s_addc_u32 s13, s21, 0
  s_mov_b32 s14, 0x400000
  s_mov_b32 s15, 0x20000
  v_lshlrev_b32 v2, 4, v4
  v_lshl_add_u32 v2, v3, 10, v2
  s_lshl_b32 s6, s4, 8
  s_add_u32 s52, s38, s6
  s_addc_u32 s53, s39, 0
  s_add_u32 s40, s38, 0x2000
  s_addc_u32 s41, s39, 0
  s_and_b32 s6, s4, 15
  s_lshl_b32 s6, s6, 11
  s_lshr_b32 s7, s4, 4
  s_lshl_b32 s7, s7, 18
  s_add_u32 s6, s6, s7
  s_add_u32 s6, s6, 2097152
  s_add_u32 s84, s38, s6
  s_addc_u32 s85, s39, 0
  s_mov_b32 s86, 262144
  s_mov_b32 s87, 0x20000
  s_mov_b32 s50, 10
  s_mov_b32 s55, 1
  s_mov_b32 s58, 0x3db504f3
  s_mov_b32 s59, 0x3fb8aa3b
  s_mov_b32 s61, 0xffff0000
  v_and_b32 v61, 1, v4
  v_lshlrev_b32 v61, 4, v61
  v_mov_b32 v60, 0xffff
  v_lshlrev_b32 v61, v61, v60
  v_lshrrev_b32 v60, 1, v4
  v_cmp_eq_u32 vcc, 0, v60
  s_nop 1
  v_cndmask_b32 v24, 0, v61, vcc
  v_cmp_eq_u32 vcc, 1, v60
  s_nop 1
  v_cndmask_b32 v25, 0, v61, vcc
  v_cmp_eq_u32 vcc, 2, v60
  s_nop 1
  v_cndmask_b32 v26, 0, v61, vcc
  v_cmp_eq_u32 vcc, 3, v60
  s_nop 1
  v_cndmask_b32 v27, 0, v61, vcc
  v_and_b32 v3, 60, v0
  s_lshl_b32 s6, s3, 6
  s_add_u32 s6, s6, 73728
  v_add_u32 v4, s6, v3
  v_mov_b32 v32, 0
  v_mov_b32 v33, 0
  v_mov_b32 v34, 0
  v_mov_b32 v35, 0
  v_mov_b32 v57, 0
  v_mov_b32 v58, 0xfe967699
  v_mul_f32 v59, s59, v58
  s_waitcnt vmcnt(4)
  s_waitcnt vmcnt(5)
  buffer_load_dwordx4 v[96:99], v1, s[8:11], s48 offen offset:0 nt
  s_waitcnt vmcnt(5)
  buffer_load_dwordx4 v[100:103], v1, s[8:11], s48 offen offset:1024 nt
  s_waitcnt vmcnt(5)
  buffer_load_dwordx4 v[104:107], v1, s[8:11], s48 offen offset:2048 nt
  s_waitcnt vmcnt(5)
  buffer_load_dwordx4 v[108:111], v1, s[8:11], s48 offen offset:3072 nt
  s_waitcnt vmcnt(4)
  s_waitcnt vmcnt(5)
  buffer_load_dwordx4 v[112:115], v1, s[8:11], s49 offen offset:0 nt
  s_waitcnt vmcnt(5)
  buffer_load_dwordx4 v[116:119], v1, s[8:11], s49 offen offset:1024 nt
  s_waitcnt vmcnt(5)
  buffer_load_dwordx4 v[120:123], v1, s[8:11], s49 offen offset:2048 nt
  s_waitcnt vmcnt(5)
  buffer_load_dwordx4 v[124:127], v1, s[8:11], s49 offen offset:3072 nt
  s_sub_u32 s48, s48, 131072
  s_and_b32 s48, s48, 2097151
  s_xor_b32 s49, s48, 2097152
  s_waitcnt vmcnt(4)
  s_waitcnt vmcnt(5)
  buffer_load_dwordx4 v[128:131], v1, s[8:11], s48 offen offset:0 nt
  s_waitcnt vmcnt(5)
  buffer_load_dwordx4 v[132:135], v1, s[8:11], s48 offen offset:1024 nt
  s_waitcnt vmcnt(5)
  buffer_load_dwordx4 v[136:139], v1, s[8:11], s48 offen offset:2048 nt
  s_waitcnt vmcnt(5)
  buffer_load_dwordx4 v[140:143], v1, s[8:11], s48 offen offset:3072 nt
  s_waitcnt vmcnt(4)
  s_waitcnt vmcnt(5)
  buffer_load_dwordx4 v[144:147], v1, s[8:11], s49 offen offset:0 nt
  s_waitcnt vmcnt(5)
  buffer_load_dwordx4 v[148:151], v1, s[8:11], s49 offen offset:1024 nt
  s_waitcnt vmcnt(5)
  buffer_load_dwordx4 v[152:155], v1, s[8:11], s49 offen offset:2048 nt
  s_waitcnt vmcnt(5)
  buffer_load_dwordx4 v[156:159], v1, s[8:11], s49 offen offset:3072 nt
  s_sub_u32 s48, s48, 131072
  s_and_b32 s48, s48, 2097151
  s_xor_b32 s49, s48, 2097152
  s_waitcnt vmcnt(4)
  s_waitcnt vmcnt(5)
  buffer_load_dwordx4 v[160:163], v1, s[8:11], s48 offen offset:0 nt
  s_waitcnt vmcnt(5)
  buffer_load_dwordx4 v[164:167], v1, s[8:11], s48 offen offset:1024 nt
  s_waitcnt vmcnt(5)
  buffer_load_dwordx4 v[168:171], v1, s[8:11], s48 offen offset:2048 nt
  s_waitcnt vmcnt(5)
  buffer_load_dwordx4 v[172:175], v1, s[8:11], s48 offen offset:3072 nt
  s_waitcnt vmcnt(4)
  s_waitcnt vmcnt(5)
  buffer_load_dwordx4 v[176:179], v1, s[8:11], s49 offen offset:0 nt
  s_waitcnt vmcnt(5)
  buffer_load_dwordx4 v[180:183], v1, s[8:11], s49 offen offset:1024 nt
  s_waitcnt vmcnt(5)
  buffer_load_dwordx4 v[184:187], v1, s[8:11], s49 offen offset:2048 nt
  s_waitcnt vmcnt(5)
  buffer_load_dwordx4 v[188:191], v1, s[8:11], s49 offen offset:3072 nt
  s_sub_u32 s48, s48, 131072
  s_and_b32 s48, s48, 2097151
  s_xor_b32 s49, s48, 2097152
  s_waitcnt vmcnt(4)
  s_waitcnt vmcnt(5)
  buffer_load_dwordx4 v[192:195], v1, s[8:11], s48 offen offset:0 nt
  s_waitcnt vmcnt(5)
  buffer_load_dwordx4 v[196:199], v1, s[8:11], s48 offen offset:1024 nt
  s_waitcnt vmcnt(5)
  buffer_load_dwordx4 v[200:203], v1, s[8:11], s48 offen offset:2048 nt
  s_waitcnt vmcnt(5)
  buffer_load_dwordx4 v[204:207], v1, s[8:11], s48 offen offset:3072 nt
  s_waitcnt vmcnt(4)
  s_waitcnt vmcnt(5)
  buffer_load_dwordx4 v[208:211], v1, s[8:11], s49 offen offset:0 nt
  s_waitcnt vmcnt(5)
  buffer_load_dwordx4 v[212:215], v1, s[8:11], s49 offen offset:1024 nt
  s_waitcnt vmcnt(5)
  buffer_load_dwordx4 v[216:219], v1, s[8:11], s49 offen offset:2048 nt
  s_waitcnt vmcnt(5)
  buffer_load_dwordx4 v[220:223], v1, s[8:11], s49 offen offset:3072 nt
  s_sub_u32 s48, s48, 131072
  s_and_b32 s48, s48, 2097151
  s_xor_b32 s49, s48, 2097152
  s_waitcnt vmcnt(4)
  s_waitcnt vmcnt(5)
  buffer_load_dwordx4 v[224:227], v1, s[8:11], s48 offen offset:0 nt
  s_waitcnt vmcnt(5)
  buffer_load_dwordx4 v[228:231], v1, s[8:11], s48 offen offset:1024 nt
  s_waitcnt vmcnt(5)
  buffer_load_dwordx4 v[232:235], v1, s[8:11], s48 offen offset:2048 nt
  s_waitcnt vmcnt(5)
  buffer_load_dwordx4 v[236:239], v1, s[8:11], s48 offen offset:3072 nt
  s_waitcnt vmcnt(4)
  s_waitcnt vmcnt(5)
  buffer_load_dwordx4 v[240:243], v1, s[8:11], s49 offen offset:0 nt
  s_waitcnt vmcnt(5)
  buffer_load_dwordx4 v[244:247], v1, s[8:11], s49 offen offset:1024 nt
  s_waitcnt vmcnt(5)
  buffer_load_dwordx4 v[248:251], v1, s[8:11], s49 offen offset:2048 nt
  s_waitcnt vmcnt(5)
  buffer_load_dwordx4 v[252:255], v1, s[8:11], s49 offen offset:3072 nt
  s_sub_u32 s48, s48, 131072
  s_and_b32 s48, s48, 2097151
  s_xor_b32 s49, s48, 2097152
  s_barrier
  ds_read_b128 v[36:39], v6 offset:0
  s_waitcnt lgkmcnt(0)
  s_mul_i32 s60, s60, 1664525
  s_add_u32 s60, s60, 1013904223
  v_cmp_eq_u32 vcc, 0, v5
  s_nop 1
  v_cndmask_b32 v8, 0, v36, vcc
  v_cndmask_b32 v9, 0, v37, vcc
  v_cndmask_b32 v10, 0, v38, vcc
  v_cndmask_b32 v11, 0, v39, vcc
  v_cmp_eq_u32 vcc, 1, v5
  s_nop 1
  v_cndmask_b32 v12, 0, v36, vcc
  v_cndmask_b32 v13, 0, v37, vcc
  v_cndmask_b32 v14, 0, v38, vcc
  v_cndmask_b32 v15, 0, v39, vcc
  v_cmp_eq_u32 vcc, 2, v5
  s_nop 1
  v_cndmask_b32 v16, 0, v36, vcc
  v_cndmask_b32 v17, 0, v37, vcc
  v_cndmask_b32 v18, 0, v38, vcc
  v_cndmask_b32 v19, 0, v39, vcc
  v_cmp_eq_u32 vcc, 3, v5
  s_nop 1
  v_cndmask_b32 v20, 0, v36, vcc
  v_cndmask_b32 v21, 0, v37, vcc
  v_cndmask_b32 v22, 0, v38, vcc
  v_cndmask_b32 v23, 0, v39, vcc
  s_branch L_extras
L_kloop:
  s_waitcnt vmcnt(4)
  v_mfma_f32_16x16x32_bf16 v[28:31], v[8:11], v[64:67], 0
  v_mfma_f32_16x16x32_bf16 v[28:31], v[12:15], v[68:71], v[28:31]
  v_mfma_f32_16x16x32_bf16 v[28:31], v[16:19], v[72:75], v[28:31]
  v_mfma_f32_16x16x32_bf16 v[28:31], v[20:23], v[76:79], v[28:31]
  buffer_load_dwordx4 v[64:67], v1, s[8:11], s48 offen offset:0 nt
  buffer_load_dwordx4 v[68:71], v1, s[8:11], s48 offen offset:1024 nt
  s_nop 5
  v_mov_b32_dpp v52, v28 quad_perm:[0,0,0,0] row_mask:0xf bank_mask:0xf
  v_mov_b32_dpp v53, v30 quad_perm:[2,2,2,2] row_mask:0xf bank_mask:0xf
  s_nop 0
  v_add_f32_dpp v52, v29, v52 quad_perm:[1,1,1,1] row_mask:0xf bank_mask:0xf
  v_add_f32_dpp v53, v31, v53 quad_perm:[3,3,3,3] row_mask:0xf bank_mask:0xf
  v_add_f32 v62, v52, v53
  v_cvt_pk_bf16_f32 v62, v62, v62
  v_and_b32 v62, s61, v62
  v_mul_f32 v62, s58, v62
  s_waitcnt vmcnt(4)
  buffer_load_dwordx4 v[72:75], v1, s[8:11], s48 offen offset:2048 nt
  s_waitcnt vmcnt(4)
  buffer_load_dwordx4 v[76:79], v1, s[8:11], s48 offen offset:3072 nt
  s_waitcnt vmcnt(4)
  v_mfma_f32_16x16x32_bf16 v[28:31], v[8:11], v[80:83], 0
  v_mfma_f32_16x16x32_bf16 v[28:31], v[12:15], v[84:87], v[28:31]
  v_mfma_f32_16x16x32_bf16 v[28:31], v[16:19], v[88:91], v[28:31]
  v_mfma_f32_16x16x32_bf16 v[28:31], v[20:23], v[92:95], v[28:31]
  buffer_load_dwordx4 v[80:83], v1, s[8:11], s49 offen offset:0 nt
  buffer_load_dwordx4 v[84:87], v1, s[8:11], s49 offen offset:1024 nt
  s_nop 5
  v_mov_b32_dpp v52, v28 quad_perm:[0,0,0,0] row_mask:0xf bank_mask:0xf
  v_mov_b32_dpp v53, v30 quad_perm:[2,2,2,2] row_mask:0xf bank_mask:0xf
  s_nop 0
  v_add_f32_dpp v52, v29, v52 quad_perm:[1,1,1,1] row_mask:0xf bank_mask:0xf
  v_add_f32_dpp v53, v31, v53 quad_perm:[3,3,3,3] row_mask:0xf bank_mask:0xf
  v_add_f32 v63, v52, v53
  v_cvt_pk_bf16_f32 v63, v63, v63
  v_and_b32 v63, s61, v63
  v_mul_f32 v63, s58, v63
  v_cvt_pk_bf16_f32 v56, v62, v63
  v_lshlrev_b32 v62, 16, v56
  v_and_b32 v63, s61, v56
  v_max_f32 v54, v62, v63
  v_cmp_gt_f32 vcc, v54, v58
  s_cbranch_vccnz L_stubk
L_retk:
  v_fma_f32 v62, v62, s59, -v59
  v_fma_f32 v63, v63, s59, -v59
  v_exp_f32 v62, v62
  v_exp_f32 v63, v63
  v_add_f32 v57, v57, v62
  v_add_f32 v57, v57, v63
  s_waitcnt vmcnt(4)
  buffer_load_dwordx4 v[88:91], v1, s[8:11], s49 offen offset:2048 nt
  s_waitcnt vmcnt(4)
  buffer_load_dwordx4 v[92:95], v1, s[8:11], s49 offen offset:3072 nt
  s_lshr_b32 s54, s42, 17
  s_lshl_b32 s54, s54, 8
  v_add_u32 v60, s54, v4
  ds_write_b32 v60, v56
  s_mov_b32 s42, s48
  s_sub_u32 s48, s48, 131072
  s_and_b32 s48, s48, 2097151
  s_xor_b32 s49, s48, 2097152
  s_sub_u32 s50, s50, 1
  s_cmp_lg_u32 s55, 0
  s_cbranch_scc1 L_coret
L_kchk:
  s_cmp_lg_u32 s50, 0
  s_cbranch_scc1 L_kloop
  s_xor_b32 s43, s46, 2097152
  s_waitcnt vmcnt(4)
  v_mfma_f32_16x16x32_bf16 v[28:31], v[8:11], v[64:67], 0
  v_mfma_f32_16x16x32_bf16 v[28:31], v[12:15], v[68:71], v[28:31]
  v_mfma_f32_16x16x32_bf16 v[28:31], v[16:19], v[72:75], v[28:31]
  v_mfma_f32_16x16x32_bf16 v[28:31], v[20:23], v[76:79], v[28:31]
  buffer_load_dwordx4 v[64:67], v2, s[12:15], s46 offen offset:0 nt
  buffer_load_dwordx4 v[68:71], v2, s[12:15], s46 offen offset:256 nt
  s_nop 5
  v_mov_b32_dpp v52, v28 quad_perm:[0,0,0,0] row_mask:0xf bank_mask:0xf
  v_mov_b32_dpp v53, v30 quad_perm:[2,2,2,2] row_mask:0xf bank_mask:0xf
  s_nop 0
  v_add_f32_dpp v52, v29, v52 quad_perm:[1,1,1,1] row_mask:0xf bank_mask:0xf
  v_add_f32_dpp v53, v31, v53 quad_perm:[3,3,3,3] row_mask:0xf bank_mask:0xf
  v_add_f32 v62, v52, v53
  v_cvt_pk_bf16_f32 v62, v62, v62
  v_and_b32 v62, s61, v62
  v_mul_f32 v62, s58, v62
  s_waitcnt vmcnt(4)
  buffer_load_dwordx4 v[72:75], v2, s[12:15], s46 offen offset:512 nt
  s_waitcnt vmcnt(4)
  buffer_load_dwordx4 v[76:79], v2, s[12:15], s46 offen offset:768 nt
  s_waitcnt vmcnt(4)
  v_mfma_f32_16x16x32_bf16 v[28:31], v[8:11], v[80:83], 0
  v_mfma_f32_16x16x32_bf16 v[28:31], v[12:15], v[84:87], v[28:31]
  v_mfma_f32_16x16x32_bf16 v[28:31], v[16:19], v[88:91], v[28:31]
  v_mfma_f32_16x16x32_bf16 v[28:31], v[20:23], v[92:95], v[28:31]
  buffer_load_dwordx4 v[80:83], v2, s[12:15], s43 offen offset:0 nt
  buffer_load_dwordx4 v[84:87], v2, s[12:15], s43 offen offset:256 nt
  s_nop 5
  v_mov_b32_dpp v52, v28 quad_perm:[0,0,0,0] row_mask:0xf bank_mask:0xf
  v_mov_b32_dpp v53, v30 quad_perm:[2,2,2,2] row_mask:0xf bank_mask:0xf
  s_nop 0
  v_add_f32_dpp v52, v29, v52 quad_perm:[1,1,1,1] row_mask:0xf bank_mask:0xf
  v_add_f32_dpp v53, v31, v53 quad_perm:[3,3,3,3] row_mask:0xf bank_mask:0xf
  v_add_f32 v63, v52, v53
  v_cvt_pk_bf16_f32 v63, v63, v63
  v_and_b32 v63, s61, v63
  v_mul_f32 v63, s58, v63
  v_cvt_pk_bf16_f32 v56, v62, v63
  v_lshlrev_b32 v62, 16, v56
  v_and_b32 v63, s61, v56
  v_max_f32 v54, v62, v63
  v_cmp_gt_f32 vcc, v54, v58
  s_cbranch_vccnz L_stubp
L_retp:
  v_fma_f32 v62, v62, s59, -v59
  v_fma_f32 v63, v63, s59, -v59
  v_exp_f32 v62, v62
  v_exp_f32 v63, v63
  v_add_f32 v57, v57, v62
  v_add_f32 v57, v57, v63
  s_waitcnt vmcnt(4)
  buffer_load_dwordx4 v[88:91], v2, s[12:15], s43 offen offset:512 nt
  s_waitcnt vmcnt(4)
  buffer_load_dwordx4 v[92:95], v2, s[12:15], s43 offen offset:768 nt
  ds_write_b32 v4, v56 offset:0
  ds_read_b32 v7, v4
  v_add_f32_dpp v57, v57, v57 row_ror:4 row_mask:0xf bank_mask:0xf
  s_nop 1
  v_add_f32_dpp v57, v57, v57 row_ror:8 row_mask:0xf bank_mask:0xf
  v_mov_b32 v61, v57
  s_nop 1
  v_permlane16_swap_b32 v61, v57
  s_nop 0
  v_add_f32 v57, v57, v61
  v_mov_b32 v61, v57
  s_nop 1
  v_permlane32_swap_b32 v61, v57
  s_nop 0
  v_add_f32 v57, v57, v61
  v_log_f32 v55, v57
  s_lshl_b32 s7, s3, 2
  s_add_u32 s7, s7, 272
  v_mov_b32 v52, s7
  v_add_f32 v55, v55, v59
  ds_write_b32 v52, v55
  v_mov_b32 v60, 256
  v_mov_b32 v61, 1
  s_mov_b64 exec, 1
  ds_add_u32 v60, v61
  s_mov_b64 exec, -1
  s_lshl_b32 s6, s4, 10
  s_add_u32 s6, s6, 131072
  v_and_b32 v8, 7, v0
  v_lshl_add_u32 v8, v8, 7, s6
  s_lshl_b32 s6, s4, 14
  s_lshl_b32 s7, s5, 8
  s_add_u32 s7, s7, s6
  s_add_u32 s7, s7, 524288
  v_lshl_add_u32 v9, v0, 3, s7
  v_lshlrev_b32 v17, 4, v0
  s_lshl_b32 s7, s3, 9
  v_add_u32 v18, s7, v17
  v_mov_b32 v19, 292
  v_mov_b32 v20, 0
  s_nop 0
  v_writelane_b32 v20, 1, 0
  s_mov_b32 s42, s46
  s_mov_b32 s50, 13
  s_mov_b32 s55, 1
  s_mov_b32 s44, 0x100000
L_vloop:
  s_waitcnt lgkmcnt(0)
  v_lshlrev_b32 v62, 16, v7
  v_and_b32 v63, s61, v7
  v_add_u32 v4, 256, v4
  s_add_u32 s42, s42, 131072
  s_xor_b32 s43, s42, 2097152
  ds_read_b32 v7, v4
  v_fma_f32 v55, v62, s59, -v59
  v_exp_f32 v55, v55
  s_nop 0
  v_cvt_pk_bf16_f32 v56, v55, v55
  s_nop 1
  v_and_b32_dpp v36, v56, v24 row_newbcast:0 row_mask:0xf bank_mask:0xf
  v_and_b32_dpp v37, v56, v25 row_newbcast:0 row_mask:0xf bank_mask:0xf
  v_and_b32_dpp v38, v56, v26 row_newbcast:0 row_mask:0xf bank_mask:0xf
  v_and_b32_dpp v39, v56, v27 row_newbcast:0 row_mask:0xf bank_mask:0xf
  v_and_b32_dpp v40, v56, v24 row_newbcast:4 row_mask:0xf bank_mask:0xf
  v_and_b32_dpp v41, v56, v25 row_newbcast:4 row_mask:0xf bank_mask:0xf
  v_and_b32_dpp v42, v56, v26 row_newbcast:4 row_mask:0xf bank_mask:0xf
  v_and_b32_dpp v43, v56, v27 row_newbcast:4 row_mask:0xf bank_mask:0xf
  v_and_b32_dpp v44, v56, v24 row_newbcast:8 row_mask:0xf bank_mask:0xf
  v_and_b32_dpp v45, v56, v25 row_newbcast:8 row_mask:0xf bank_mask:0xf
  v_and_b32_dpp v46, v56, v26 row_newbcast:8 row_mask:0xf bank_mask:0xf
  v_and_b32_dpp v47, v56, v27 row_newbcast:8 row_mask:0xf bank_mask:0xf
  v_and_b32_dpp v48, v56, v24 row_newbcast:12 row_mask:0xf bank_mask:0xf
  v_and_b32_dpp v49, v56, v25 row_newbcast:12 row_mask:0xf bank_mask:0xf
  v_and_b32_dpp v50, v56, v26 row_newbcast:12 row_mask:0xf bank_mask:0xf
  v_and_b32_dpp v51, v56, v27 row_newbcast:12 row_mask:0xf bank_mask:0xf
  s_waitcnt vmcnt(4)
  v_mfma_f32_16x16x32_bf16 v[32:35], v[36:39], v[64:67], v[32:35]
  v_mfma_f32_16x16x32_bf16 v[32:35], v[40:43], v[68:71], v[32:35]
  v_mfma_f32_16x16x32_bf16 v[32:35], v[44:47], v[72:75], v[32:35]
  v_mfma_f32_16x16x32_bf16 v[32:35], v[48:51], v[76:79], v[32:35]
  buffer_load_dwordx4 v[64:67], v2, s[12:15], s42 offen offset:0 nt
  buffer_load_dwordx4 v[68:71], v2, s[12:15], s42 offen offset:256 nt
  v_fma_f32 v55, v63, s59, -v59
  v_exp_f32 v55, v55
  s_nop 0
  v_cvt_pk_bf16_f32 v56, v55, v55
  s_nop 1
  v_and_b32_dpp v36, v56, v24 row_newbcast:0 row_mask:0xf bank_mask:0xf
  v_and_b32_dpp v37, v56, v25 row_newbcast:0 row_mask:0xf bank_mask:0xf
  v_and_b32_dpp v38, v56, v26 row_newbcast:0 row_mask:0xf bank_mask:0xf
  v_and_b32_dpp v39, v56, v27 row_newbcast:0 row_mask:0xf bank_mask:0xf
  v_and_b32_dpp v40, v56, v24 row_newbcast:4 row_mask:0xf bank_mask:0xf
  v_and_b32_dpp v41, v56, v25 row_newbcast:4 row_mask:0xf bank_mask:0xf
  v_and_b32_dpp v42, v56, v26 row_newbcast:4 row_mask:0xf bank_mask:0xf
  v_and_b32_dpp v43, v56, v27 row_newbcast:4 row_mask:0xf bank_mask:0xf
  v_and_b32_dpp v44, v56, v24 row_newbcast:8 row_mask:0xf bank_mask:0xf
  v_and_b32_dpp v45, v56, v25 row_newbcast:8 row_mask:0xf bank_mask:0xf
  v_and_b32_dpp v46, v56, v26 row_newbcast:8 row_mask:0xf bank_mask:0xf
  v_and_b32_dpp v47, v56, v27 row_newbcast:8 row_mask:0xf bank_mask:0xf
  v_and_b32_dpp v48, v56, v24 row_newbcast:12 row_mask:0xf bank_mask:0xf
  v_and_b32_dpp v49, v56, v25 row_newbcast:12 row_mask:0xf bank_mask:0xf
  v_and_b32_dpp v50, v56, v26 row_newbcast:12 row_mask:0xf bank_mask:0xf
  v_and_b32_dpp v51, v56, v27 row_newbcast:12 row_mask:0xf bank_mask:0xf
  s_waitcnt vmcnt(4)
  buffer_load_dwordx4 v[72:75], v2, s[12:15], s42 offen offset:512 nt
  s_waitcnt vmcnt(4)
  buffer_load_dwordx4 v[76:79], v2, s[12:15], s42 offen offset:768 nt
  s_waitcnt vmcnt(4)
  v_mfma_f32_16x16x32_bf16 v[32:35], v[36:39], v[80:83], v[32:35]
  v_mfma_f32_16x16x32_bf16 v[32:35], v[40:43], v[84:87], v[32:35]
  v_mfma_f32_16x16x32_bf16 v[32:35], v[44:47], v[88:91], v[32:35]
  v_mfma_f32_16x16x32_bf16 v[32:35], v[48:51], v[92:95], v[32:35]
  buffer_load_dwordx4 v[80:83], v2, s[12:15], s43 offen offset:0 nt
  buffer_load_dwordx4 v[84:87], v2, s[12:15], s43 offen offset:256 nt
  s_waitcnt vmcnt(4)
  buffer_load_dwordx4 v[88:91], v2, s[12:15], s43 offen offset:512 nt
  s_waitcnt vmcnt(4)
  buffer_load_dwordx4 v[92:95], v2, s[12:15], s43 offen offset:768 nt
  s_sub_u32 s50, s50, 1
  s_cmp_gt_u32 s50, 1
  s_cbranch_scc1 L_vloop
  s_cmp_eq_u32 s50, 1
  s_cbranch_scc1 L_lamld
  v_mov_b32 v12, 288
  v_mov_b32 v13, 1
  s_waitcnt lgkmcnt(0)
L_dloop:
  s_mov_b64 exec, 1
  ds_add_rtn_u32 v14, v12, v13
  s_mov_b64 exec, -1
  s_waitcnt vmcnt(8)
  v_lshlrev_b32 v62, 16, v7
  v_and_b32 v63, s61, v7
  v_fma_f32 v55, v62, s59, -v59
  v_exp_f32 v55, v55
  s_nop 0
  v_cvt_pk_bf16_f32 v56, v55, v55
  s_nop 1
  v_and_b32_dpp v36, v56, v24 row_newbcast:0 row_mask:0xf bank_mask:0xf
  v_and_b32_dpp v37, v56, v25 row_newbcast:0 row_mask:0xf bank_mask:0xf
  v_and_b32_dpp v38, v56, v26 row_newbcast:0 row_mask:0xf bank_mask:0xf
  v_and_b32_dpp v39, v56, v27 row_newbcast:0 row_mask:0xf bank_mask:0xf
  v_and_b32_dpp v40, v56, v24 row_newbcast:4 row_mask:0xf bank_mask:0xf
  v_and_b32_dpp v41, v56, v25 row_newbcast:4 row_mask:0xf bank_mask:0xf
  v_and_b32_dpp v42, v56, v26 row_newbcast:4 row_mask:0xf bank_mask:0xf
  v_and_b32_dpp v43, v56, v27 row_newbcast:4 row_mask:0xf bank_mask:0xf
  v_and_b32_dpp v44, v56, v24 row_newbcast:8 row_mask:0xf bank_mask:0xf
  v_and_b32_dpp v45, v56, v25 row_newbcast:8 row_mask:0xf bank_mask:0xf
  v_and_b32_dpp v46, v56, v26 row_newbcast:8 row_mask:0xf bank_mask:0xf
  v_and_b32_dpp v47, v56, v27 row_newbcast:8 row_mask:0xf bank_mask:0xf
  v_and_b32_dpp v48, v56, v24 row_newbcast:12 row_mask:0xf bank_mask:0xf
  v_and_b32_dpp v49, v56, v25 row_newbcast:12 row_mask:0xf bank_mask:0xf
  v_and_b32_dpp v50, v56, v26 row_newbcast:12 row_mask:0xf bank_mask:0xf
  v_and_b32_dpp v51, v56, v27 row_newbcast:12 row_mask:0xf bank_mask:0xf
  s_waitcnt lgkmcnt(0)
  v_readfirstlane_b32 s45, v14
  s_and_b32 s6, s45, -4
  s_add_u32 s6, s6, 512
  v_mov_b32 v15, s6
  s_and_b32 s45, s45, 3
  s_waitcnt vmcnt(4)
  ds_read_b32 v16, v15
  v_mfma_f32_16x16x32_bf16 v[32:35], v[36:39], v[64:67], v[32:35]
  v_mfma_f32_16x16x32_bf16 v[32:35], v[40:43], v[68:71], v[32:35]
  v_mfma_f32_16x16x32_bf16 v[32:35], v[44:47], v[72:75], v[32:35]
  v_mfma_f32_16x16x32_bf16 v[32:35], v[48:51], v[76:79], v[32:35]
  s_cmp_lg_u32 s55, 0
  s_cbranch_scc1 L_gate
L_gate_ret:
  s_waitcnt lgkmcnt(0)
  v_readfirstlane_b32 s54, v16
  s_cmp_eq_u32 s54, 0
  s_cbranch_scc1 L_respin
  s_lshl_b32 s54, s54, 2
  s_add_u32 s54, s54, s45
  s_add_u32 s54, s54, 444
  s_cmp_ge_u32 s54, 512
  s_cbranch_scc1 L_last
  s_lshl_b32 s42, s54, 12
  s_lshr_b32 s6, s54, 5
  s_sub_u32 s6, s6, 14
  s_lshl_b32 s6, s6, 15
  s_and_b32 s54, s54, 31
  s_lshl_b32 s54, s54, 6
  s_add_u32 s54, s54, s6
  buffer_load_dword v7, v3, s[84:87], s54 offen sc1
  buffer_load_dwordx4 v[64:67], v2, s[12:15], s42 offen offset:0 nt
  buffer_load_dwordx4 v[68:71], v2, s[12:15], s42 offen offset:256 nt
  s_xor_b32 s43, s42, 2097152
  v_fma_f32 v55, v63, s59, -v59
  v_exp_f32 v55, v55
  s_nop 0
  v_cvt_pk_bf16_f32 v56, v55, v55
  s_nop 1
  v_and_b32_dpp v36, v56, v24 row_newbcast:0 row_mask:0xf bank_mask:0xf
  v_and_b32_dpp v37, v56, v25 row_newbcast:0 row_mask:0xf bank_mask:0xf
  v_and_b32_dpp v38, v56, v26 row_newbcast:0 row_mask:0xf bank_mask:0xf
  v_and_b32_dpp v39, v56, v27 row_newbcast:0 row_mask:0xf bank_mask:0xf
  v_and_b32_dpp v40, v56, v24 row_newbcast:4 row_mask:0xf bank_mask:0xf
  v_and_b32_dpp v41, v56, v25 row_newbcast:4 row_mask:0xf bank_mask:0xf
  v_and_b32_dpp v42, v56, v26 row_newbcast:4 row_mask:0xf bank_mask:0xf
  v_and_b32_dpp v43, v56, v27 row_newbcast:4 row_mask:0xf bank_mask:0xf
  v_and_b32_dpp v44, v56, v24 row_newbcast:8 row_mask:0xf bank_mask:0xf
  v_and_b32_dpp v45, v56, v25 row_newbcast:8 row_mask:0xf bank_mask:0xf
  v_and_b32_dpp v46, v56, v26 row_newbcast:8 row_mask:0xf bank_mask:0xf
  v_and_b32_dpp v47, v56, v27 row_newbcast:8 row_mask:0xf bank_mask:0xf
  v_and_b32_dpp v48, v56, v24 row_newbcast:12 row_mask:0xf bank_mask:0xf
  v_and_b32_dpp v49, v56, v25 row_newbcast:12 row_mask:0xf bank_mask:0xf
  v_and_b32_dpp v50, v56, v26 row_newbcast:12 row_mask:0xf bank_mask:0xf
  v_and_b32_dpp v51, v56, v27 row_newbcast:12 row_mask:0xf bank_mask:0xf
  s_waitcnt vmcnt(5)
  buffer_load_dwordx4 v[72:75], v2, s[12:15], s42 offen offset:512 nt
  s_waitcnt vmcnt(5)
  buffer_load_dwordx4 v[76:79], v2, s[12:15], s42 offen offset:768 nt
  s_waitcnt vmcnt(5)
  v_mfma_f32_16x16x32_bf16 v[32:35], v[36:39], v[80:83], v[32:35]
  v_mfma_f32_16x16x32_bf16 v[32:35], v[40:43], v[84:87], v[32:35]
  v_mfma_f32_16x16x32_bf16 v[32:35], v[44:47], v[88:91], v[32:35]
  v_mfma_f32_16x16x32_bf16 v[32:35], v[48:51], v[92:95], v[32:35]
  buffer_load_dwordx4 v[80:83], v2, s[12:15], s43 offen offset:0 nt
  buffer_load_dwordx4 v[84:87], v2, s[12:15], s43 offen offset:256 nt
  s_waitcnt vmcnt(4)
  buffer_load_dwordx4 v[88:91], v2, s[12:15], s43 offen offset:512 nt
  s_waitcnt vmcnt(4)
  buffer_load_dwordx4 v[92:95], v2, s[12:15], s43 offen offset:768 nt
  s_branch L_dloop
L_respin:
  s_sub_u32 s44, s44, 1
  s_cbranch_scc1 L_abort
  ds_read_b32 v16, v15
  s_branch L_gate_ret
L_lamld:
  s_mov_b64 exec, 0xff
  global_load_dwordx2 v[10:11], v8, s[38:39] sc1
  s_mov_b64 exec, -1
  s_branch L_vloop
L_last:
  v_fma_f32 v55, v63, s59, -v59
  v_exp_f32 v55, v55
  s_nop 0
  v_cvt_pk_bf16_f32 v56, v55, v55
  s_nop 1
  v_and_b32_dpp v36, v56, v24 row_newbcast:0 row_mask:0xf bank_mask:0xf
  v_and_b32_dpp v37, v56, v25 row_newbcast:0 row_mask:0xf bank_mask:0xf
  v_and_b32_dpp v38, v56, v26 row_newbcast:0 row_mask:0xf bank_mask:0xf
  v_and_b32_dpp v39, v56, v27 row_newbcast:0 row_mask:0xf bank_mask:0xf
  v_and_b32_dpp v40, v56, v24 row_newbcast:4 row_mask:0xf bank_mask:0xf
  v_and_b32_dpp v41, v56, v25 row_newbcast:4 row_mask:0xf bank_mask:0xf
  v_and_b32_dpp v42, v56, v26 row_newbcast:4 row_mask:0xf bank_mask:0xf
  v_and_b32_dpp v43, v56, v27 row_newbcast:4 row_mask:0xf bank_mask:0xf
  v_and_b32_dpp v44, v56, v24 row_newbcast:8 row_mask:0xf bank_mask:0xf
  v_and_b32_dpp v45, v56, v25 row_newbcast:8 row_mask:0xf bank_mask:0xf
  v_and_b32_dpp v46, v56, v26 row_newbcast:8 row_mask:0xf bank_mask:0xf
  v_and_b32_dpp v47, v56, v27 row_newbcast:8 row_mask:0xf bank_mask:0xf
  v_and_b32_dpp v48, v56, v24 row_newbcast:12 row_mask:0xf bank_mask:0xf
  v_and_b32_dpp v49, v56, v25 row_newbcast:12 row_mask:0xf bank_mask:0xf
  v_and_b32_dpp v50, v56, v26 row_newbcast:12 row_mask:0xf bank_mask:0xf
  v_and_b32_dpp v51, v56, v27 row_newbcast:12 row_mask:0xf bank_mask:0xf
  s_waitcnt vmcnt(0)
  v_mfma_f32_16x16x32_bf16 v[32:35], v[36:39], v[80:83], v[32:35]
  v_mfma_f32_16x16x32_bf16 v[32:35], v[40:43], v[84:87], v[32:35]
  v_mfma_f32_16x16x32_bf16 v[32:35], v[44:47], v[88:91], v[32:35]
  v_mfma_f32_16x16x32_bf16 v[32:35], v[48:51], v[92:95], v[32:35]
L_fin:
  s_mov_b32 exec_hi, 0
  s_nop 6
  ds_write_b128 v18, v[32:35] offset:4352
  s_mov_b32 exec_lo, 1
  ds_add_rtn_u32 v21, v19, v20
  s_mov_b32 exec_lo, -1
  ds_read_b128 v[36:39], v17 offset:4352
  ds_read_b128 v[40:43], v17 offset:4864
  ds_read_b128 v[44:47], v17 offset:5376
  ds_read_b128 v[48:51], v17 offset:5888
  s_waitcnt lgkmcnt(4)
  v_readfirstlane_b32 s6, v21
  s_cmp_lg_u32 s6, 3
  s_cbranch_scc1 L_nopub
  s_waitcnt lgkmcnt(2)
  v_pk_add_f32 v[32:33], v[36:37], v[40:41]
  v_pk_add_f32 v[34:35], v[38:39], v[42:43]
  s_waitcnt lgkmcnt(0)
  v_pk_add_f32 v[36:37], v[44:45], v[48:49]
  v_pk_add_f32 v[38:39], v[46:47], v[50:51]
  v_pk_add_f32 v[32:33], v[32:33], v[36:37]
  v_pk_add_f32 v[34:35], v[34:35], v[38:39]
  v_cvt_pk_bf16_f32 v32, v32, v33
  v_cvt_pk_bf16_f32 v33, v34, v35
  v_min_u32 v32, -2, v32
  v_min_u32 v33, -2, v33
  global_store_dwordx2 v9, v[32:33], s[38:39] sc1
  global_store_dwordx2 v9, v[32:33], s[40:41] sc1
L_nopub:
  s_barrier
  s_endpgm
L_gate_re:
  s_sub_u32 s44, s44, 1
  s_cbranch_scc1 L_abort
  global_load_dwordx2 v[10:11], v8, s[38:39] sc1
  s_waitcnt vmcnt(0)
  s_branch L_gate_chk
L_gate:
  s_mov_b64 exec, 0xff
L_gate_chk:
  v_cmp_ne_u32 vcc, s60, v11
  s_cbranch_vccnz L_gate_re
  s_mov_b64 exec, -1
  v_mov_b32_dpp v10, v10 row_shr:8 row_mask:0xf bank_mask:0xc
  s_nop 1
  v_max_f32_dpp v60, v10, v10 row_ror:1 row_mask:0xf bank_mask:0xf
  s_nop 1
  v_max_f32_dpp v60, v60, v60 row_ror:2 row_mask:0xf bank_mask:0xf
  s_nop 1
  v_max_f32_dpp v60, v60, v60 row_ror:4 row_mask:0xf bank_mask:0xf
  v_sub_f32 v10, v10, v60
  v_exp_f32 v10, v10
  s_nop 1
  v_add_f32_dpp v10, v10, v10 row_ror:1 row_mask:0xf bank_mask:0xf
  s_nop 1
  v_add_f32_dpp v10, v10, v10 row_ror:2 row_mask:0xf bank_mask:0xf
  s_nop 1
  v_add_f32_dpp v10, v10, v10 row_ror:4 row_mask:0xf bank_mask:0xf
  v_log_f32 v10, v10
  s_mov_b32 s55, 0
  v_add_f32 v60, v60, v10
  s_nop 0
  v_readfirstlane_b32 s6, v60
  s_nop 1
  v_mov_b32 v60, s6
  v_sub_f32 v61, v59, v60
  v_exp_f32 v61, v61
  v_mov_b32 v59, v60
  v_mul_f32 v32, v32, v61
  v_mul_f32 v33, v33, v61
  v_mul_f32 v34, v34, v61
  v_mul_f32 v35, v35, v61
  s_branch L_gate_ret
L_coret:
  s_setpc_b64 s[62:63]
L_extras:
  s_call_b64 s[62:63], L_kloop
  s_waitcnt vmcnt(8)
  v_mfma_f32_16x16x32_bf16 v[28:31], v[8:11], v[96:99], 0
  v_mfma_f32_16x16x32_bf16 v[28:31], v[12:15], v[100:103], v[28:31]
  v_mfma_f32_16x16x32_bf16 v[28:31], v[16:19], v[104:107], v[28:31]
  v_mfma_f32_16x16x32_bf16 v[28:31], v[20:23], v[108:111], v[28:31]
  s_nop 7
  v_mov_b32_dpp v52, v28 quad_perm:[0,0,0,0] row_mask:0xf bank_mask:0xf
  v_mov_b32_dpp v53, v30 quad_perm:[2,2,2,2] row_mask:0xf bank_mask:0xf
  s_nop 0
  v_add_f32_dpp v52, v29, v52 quad_perm:[1,1,1,1] row_mask:0xf bank_mask:0xf
  v_add_f32_dpp v53, v31, v53 quad_perm:[3,3,3,3] row_mask:0xf bank_mask:0xf
  v_add_f32 v62, v52, v53
  v_cvt_pk_bf16_f32 v62, v62, v62
  v_and_b32 v62, s61, v62
  v_mul_f32 v62, s58, v62
  v_mfma_f32_16x16x32_bf16 v[28:31], v[8:11], v[112:115], 0
  v_mfma_f32_16x16x32_bf16 v[28:31], v[12:15], v[116:119], v[28:31]
  v_mfma_f32_16x16x32_bf16 v[28:31], v[16:19], v[120:123], v[28:31]
  v_mfma_f32_16x16x32_bf16 v[28:31], v[20:23], v[124:127], v[28:31]
  s_nop 7
  v_mov_b32_dpp v52, v28 quad_perm:[0,0,0,0] row_mask:0xf bank_mask:0xf
  v_mov_b32_dpp v53, v30 quad_perm:[2,2,2,2] row_mask:0xf bank_mask:0xf
  s_nop 0
  v_add_f32_dpp v52, v29, v52 quad_perm:[1,1,1,1] row_mask:0xf bank_mask:0xf
  v_add_f32_dpp v53, v31, v53 quad_perm:[3,3,3,3] row_mask:0xf bank_mask:0xf
  v_add_f32 v63, v52, v53
  v_cvt_pk_bf16_f32 v63, v63, v63
  v_and_b32 v63, s61, v63
  v_mul_f32 v63, s58, v63
  v_cvt_pk_bf16_f32 v56, v62, v63
  v_lshlrev_b32 v62, 16, v56
  v_and_b32 v63, s61, v56
  v_max_f32 v54, v62, v63
  v_cmp_gt_f32 vcc, v54, v58
  s_cbranch_vccnz L_stub1
L_ret1:
  v_fma_f32 v62, v62, s59, -v59
  v_fma_f32 v63, v63, s59, -v59
  v_exp_f32 v62, v62
  v_exp_f32 v63, v63
  v_add_f32 v57, v57, v62
  v_add_f32 v57, v57, v63
  ds_write_b32 v4, v56 offset:3584
  s_call_b64 s[62:63], L_kloop
  s_waitcnt vmcnt(8)
  v_mfma_f32_16x16x32_bf16 v[28:31], v[8:11], v[128:131], 0
  v_mfma_f32_16x16x32_bf16 v[28:31], v[12:15], v[132:135], v[28:31]
  v_mfma_f32_16x16x32_bf16 v[28:31], v[16:19], v[136:139], v[28:31]
  v_mfma_f32_16x16x32_bf16 v[28:31], v[20:23], v[140:143], v[28:31]
  s_nop 7
  v_mov_b32_dpp v52, v28 quad_perm:[0,0,0,0] row_mask:0xf bank_mask:0xf
  v_mov_b32_dpp v53, v30 quad_perm:[2,2,2,2] row_mask:0xf bank_mask:0xf
  s_nop 0
  v_add_f32_dpp v52, v29, v52 quad_perm:[1,1,1,1] row_mask:0xf bank_mask:0xf
  v_add_f32_dpp v53, v31, v53 quad_perm:[3,3,3,3] row_mask:0xf bank_mask:0xf
  v_add_f32 v62, v52, v53
  v_cvt_pk_bf16_f32 v62, v62, v62
  v_and_b32 v62, s61, v62
  v_mul_f32 v62, s58, v62
  v_mfma_f32_16x16x32_bf16 v[28:31], v[8:11], v[144:147], 0
  v_mfma_f32_16x16x32_bf16 v[28:31], v[12:15], v[148:151], v[28:31]
  v_mfma_f32_16x16x32_bf16 v[28:31], v[16:19], v[152:155], v[28:31]
  v_mfma_f32_16x16x32_bf16 v[28:31], v[20:23], v[156:159], v[28:31]
  s_nop 7
  v_mov_b32_dpp v52, v28 quad_perm:[0,0,0,0] row_mask:0xf bank_mask:0xf
  v_mov_b32_dpp v53, v30 quad_perm:[2,2,2,2] row_mask:0xf bank_mask:0xf
  s_nop 0
  v_add_f32_dpp v52, v29, v52 quad_perm:[1,1,1,1] row_mask:0xf bank_mask:0xf
  v_add_f32_dpp v53, v31, v53 quad_perm:[3,3,3,3] row_mask:0xf bank_mask:0xf
  v_add_f32 v63, v52, v53
  v_cvt_pk_bf16_f32 v63, v63, v63
  v_and_b32 v63, s61, v63
  v_mul_f32 v63, s58, v63
  v_cvt_pk_bf16_f32 v56, v62, v63
  v_lshlrev_b32 v62, 16, v56
  v_and_b32 v63, s61, v56
  v_max_f32 v54, v62, v63
  v_cmp_gt_f32 vcc, v54, v58
  s_cbranch_vccnz L_stub2
L_ret2:
  v_fma_f32 v62, v62, s59, -v59
  v_fma_f32 v63, v63, s59, -v59
  v_exp_f32 v62, v62
  v_exp_f32 v63, v63
  v_add_f32 v57, v57, v62
  v_add_f32 v57, v57, v63
  ds_write_b32 v4, v56 offset:3328
  s_call_b64 s[62:63], L_kloop
  s_waitcnt vmcnt(8)
  v_mfma_f32_16x16x32_bf16 v[28:31], v[8:11], v[160:163], 0
  v_mfma_f32_16x16x32_bf16 v[28:31], v[12:15], v[164:167], v[28:31]
  v_mfma_f32_16x16x32_bf16 v[28:31], v[16:19], v[168:171], v[28:31]
  v_mfma_f32_16x16x32_bf16 v[28:31], v[20:23], v[172:175], v[28:31]
  s_nop 7
  v_mov_b32_dpp v52, v28 quad_perm:[0,0,0,0] row_mask:0xf bank_mask:0xf
  v_mov_b32_dpp v53, v30 quad_perm:[2,2,2,2] row_mask:0xf bank_mask:0xf
  s_nop 0
  v_add_f32_dpp v52, v29, v52 quad_perm:[1,1,1,1] row_mask:0xf bank_mask:0xf
  v_add_f32_dpp v53, v31, v53 quad_perm:[3,3,3,3] row_mask:0xf bank_mask:0xf
  v_add_f32 v62, v52, v53
  v_cvt_pk_bf16_f32 v62, v62, v62
  v_and_b32 v62, s61, v62
  v_mul_f32 v62, s58, v62
  v_mfma_f32_16x16x32_bf16 v[28:31], v[8:11], v[176:179], 0
  v_mfma_f32_16x16x32_bf16 v[28:31], v[12:15], v[180:183], v[28:31]
  v_mfma_f32_16x16x32_bf16 v[28:31], v[16:19], v[184:187], v[28:31]
  v_mfma_f32_16x16x32_bf16 v[28:31], v[20:23], v[188:191], v[28:31]
  s_nop 7
  v_mov_b32_dpp v52, v28 quad_perm:[0,0,0,0] row_mask:0xf bank_mask:0xf
  v_mov_b32_dpp v53, v30 quad_perm:[2,2,2,2] row_mask:0xf bank_mask:0xf
  s_nop 0
  v_add_f32_dpp v52, v29, v52 quad_perm:[1,1,1,1] row_mask:0xf bank_mask:0xf
  v_add_f32_dpp v53, v31, v53 quad_perm:[3,3,3,3] row_mask:0xf bank_mask:0xf
  v_add_f32 v63, v52, v53
  v_cvt_pk_bf16_f32 v63, v63, v63
  v_and_b32 v63, s61, v63
  v_mul_f32 v63, s58, v63
  v_cvt_pk_bf16_f32 v56, v62, v63
  v_lshlrev_b32 v62, 16, v56
  v_and_b32 v63, s61, v56
  v_max_f32 v54, v62, v63
  v_cmp_gt_f32 vcc, v54, v58
  s_cbranch_vccnz L_stub3
L_ret3:
  v_fma_f32 v62, v62, s59, -v59
  v_fma_f32 v63, v63, s59, -v59
  v_exp_f32 v62, v62
  v_exp_f32 v63, v63
  v_add_f32 v57, v57, v62
  v_add_f32 v57, v57, v63
  ds_write_b32 v4, v56 offset:3072
  s_call_b64 s[62:63], L_kloop
  s_waitcnt vmcnt(8)
  v_mfma_f32_16x16x32_bf16 v[28:31], v[8:11], v[192:195], 0
  v_mfma_f32_16x16x32_bf16 v[28:31], v[12:15], v[196:199], v[28:31]
  v_mfma_f32_16x16x32_bf16 v[28:31], v[16:19], v[200:203], v[28:31]
  v_mfma_f32_16x16x32_bf16 v[28:31], v[20:23], v[204:207], v[28:31]
  s_nop 7
  v_mov_b32_dpp v52, v28 quad_perm:[0,0,0,0] row_mask:0xf bank_mask:0xf
  v_mov_b32_dpp v53, v30 quad_perm:[2,2,2,2] row_mask:0xf bank_mask:0xf
  s_nop 0
  v_add_f32_dpp v52, v29, v52 quad_perm:[1,1,1,1] row_mask:0xf bank_mask:0xf
  v_add_f32_dpp v53, v31, v53 quad_perm:[3,3,3,3] row_mask:0xf bank_mask:0xf
  v_add_f32 v62, v52, v53
  v_cvt_pk_bf16_f32 v62, v62, v62
  v_and_b32 v62, s61, v62
  v_mul_f32 v62, s58, v62
  v_mfma_f32_16x16x32_bf16 v[28:31], v[8:11], v[208:211], 0
  v_mfma_f32_16x16x32_bf16 v[28:31], v[12:15], v[212:215], v[28:31]
  v_mfma_f32_16x16x32_bf16 v[28:31], v[16:19], v[216:219], v[28:31]
  v_mfma_f32_16x16x32_bf16 v[28:31], v[20:23], v[220:223], v[28:31]
  s_nop 7
  v_mov_b32_dpp v52, v28 quad_perm:[0,0,0,0] row_mask:0xf bank_mask:0xf
  v_mov_b32_dpp v53, v30 quad_perm:[2,2,2,2] row_mask:0xf bank_mask:0xf
  s_nop 0
  v_add_f32_dpp v52, v29, v52 quad_perm:[1,1,1,1] row_mask:0xf bank_mask:0xf
  v_add_f32_dpp v53, v31, v53 quad_perm:[3,3,3,3] row_mask:0xf bank_mask:0xf
  v_add_f32 v63, v52, v53
  v_cvt_pk_bf16_f32 v63, v63, v63
  v_and_b32 v63, s61, v63
  v_mul_f32 v63, s58, v63
  v_cvt_pk_bf16_f32 v56, v62, v63
  v_lshlrev_b32 v62, 16, v56
  v_and_b32 v63, s61, v56
  v_max_f32 v54, v62, v63
  v_cmp_gt_f32 vcc, v54, v58
  s_cbranch_vccnz L_stub4
L_ret4:
  v_fma_f32 v62, v62, s59, -v59
  v_fma_f32 v63, v63, s59, -v59
  v_exp_f32 v62, v62
  v_exp_f32 v63, v63
  v_add_f32 v57, v57, v62
  v_add_f32 v57, v57, v63
  ds_write_b32 v4, v56 offset:2816
  s_call_b64 s[62:63], L_kloop
  s_waitcnt vmcnt(8)
  v_mfma_f32_16x16x32_bf16 v[28:31], v[8:11], v[224:227], 0
  v_mfma_f32_16x16x32_bf16 v[28:31], v[12:15], v[228:231], v[28:31]
  v_mfma_f32_16x16x32_bf16 v[28:31], v[16:19], v[232:235], v[28:31]
  v_mfma_f32_16x16x32_bf16 v[28:31], v[20:23], v[236:239], v[28:31]
  s_nop 7
  v_mov_b32_dpp v52, v28 quad_perm:[0,0,0,0] row_mask:0xf bank_mask:0xf
  v_mov_b32_dpp v53, v30 quad_perm:[2,2,2,2] row_mask:0xf bank_mask:0xf
  s_nop 0
  v_add_f32_dpp v52, v29, v52 quad_perm:[1,1,1,1] row_mask:0xf bank_mask:0xf
  v_add_f32_dpp v53, v31, v53 quad_perm:[3,3,3,3] row_mask:0xf bank_mask:0xf
  v_add_f32 v62, v52, v53
  v_cvt_pk_bf16_f32 v62, v62, v62
  v_and_b32 v62, s61, v62
  v_mul_f32 v62, s58, v62
  v_mfma_f32_16x16x32_bf16 v[28:31], v[8:11], v[240:243], 0
  v_mfma_f32_16x16x32_bf16 v[28:31], v[12:15], v[244:247], v[28:31]
  v_mfma_f32_16x16x32_bf16 v[28:31], v[16:19], v[248:251], v[28:31]
  v_mfma_f32_16x16x32_bf16 v[28:31], v[20:23], v[252:255], v[28:31]
  s_nop 7
  v_mov_b32_dpp v52, v28 quad_perm:[0,0,0,0] row_mask:0xf bank_mask:0xf
  v_mov_b32_dpp v53, v30 quad_perm:[2,2,2,2] row_mask:0xf bank_mask:0xf
  s_nop 0
  v_add_f32_dpp v52, v29, v52 quad_perm:[1,1,1,1] row_mask:0xf bank_mask:0xf
  v_add_f32_dpp v53, v31, v53 quad_perm:[3,3,3,3] row_mask:0xf bank_mask:0xf
  v_add_f32 v63, v52, v53
  v_cvt_pk_bf16_f32 v63, v63, v63
  v_and_b32 v63, s61, v63
  v_mul_f32 v63, s58, v63
  v_cvt_pk_bf16_f32 v56, v62, v63
  v_lshlrev_b32 v62, 16, v56
  v_and_b32 v63, s61, v56
  v_max_f32 v54, v62, v63
  v_cmp_gt_f32 vcc, v54, v58
  s_cbranch_vccnz L_stub5
L_ret5:
  v_fma_f32 v62, v62, s59, -v59
  v_fma_f32 v63, v63, s59, -v59
  v_exp_f32 v62, v62
  v_exp_f32 v63, v63
  v_add_f32 v57, v57, v62
  v_add_f32 v57, v57, v63
  ds_write_b32 v4, v56 offset:2560
  v_mov_b32 v60, 268
  v_mov_b32 v61, 1
  s_mov_b64 exec, 1
  ds_add_u32 v60, v61
  s_mov_b64 exec, -1
  s_mov_b32 s55, 0
  s_branch L_kchk
L_stubk:
  s_call_b64 s[56:57], L_resc
  s_branch L_retk
L_stubp:
  s_call_b64 s[56:57], L_resc
  s_branch L_retp
L_stub1:
  s_call_b64 s[56:57], L_resc
  s_branch L_ret1
L_stub2:
  s_call_b64 s[56:57], L_resc
  s_branch L_ret2
L_stub3:
  s_call_b64 s[56:57], L_resc
  s_branch L_ret3
L_stub4:
  s_call_b64 s[56:57], L_resc
  s_branch L_ret4
L_stub5:
  s_call_b64 s[56:57], L_resc
  s_branch L_ret5
L_resc:
  v_max_f32 v60, v54, v58
  s_nop 1
  v_max_f32_dpp v60, v60, v60 row_ror:4 row_mask:0xf bank_mask:0xf
  s_nop 1
  v_max_f32_dpp v60, v60, v60 row_ror:8 row_mask:0xf bank_mask:0xf
  v_mov_b32 v61, v60
  s_nop 1
  v_permlane16_swap_b32 v61, v60
  s_nop 0
  v_max_f32 v60, v60, v61
  v_mov_b32 v61, v60
  s_nop 1
  v_permlane32_swap_b32 v61, v60
  s_nop 0
  v_max_f32 v60, v60, v61
  v_mov_b32 v58, v60
  v_mul_f32 v60, s59, v60
  v_sub_f32 v61, v59, v60
  v_exp_f32 v61, v61
  v_mov_b32 v59, v60
  v_mul_f32 v57, v57, v61
  s_setpc_b64 s[56:57]
L_T:
  s_sub_u32 s3, s3, 4
  s_mov_b32 s61, 0xffff0000
  s_mov_b32 s60, 0x100000
  s_lshl_b32 s48, s5, 2
  s_add_u32 s48, s48, s4
  s_and_b32 s48, s48, 31
  s_cmp_eq_u32 s3, 0
  s_cbranch_scc1 L_q
  s_mul_i32 s49, s5, 7
  s_add_u32 s49, s49, s48
  s_cmp_eq_u32 s3, 2
  s_cbranch_scc1 L_pf
  s_waitcnt lgkmcnt(0)
  s_load_dword s63, s[38:39], 16384
  s_lshr_b32 s55, s3, 1
  s_bitcmp1_b32 s48, 3
  s_cbranch_scc0 L_nopfs
  s_and_b32 s56, s48, 7
  s_lshr_b32 s57, s48, 4
  s_lshl_b32 s57, s57, 3
  s_add_u32 s56, s56, s57
  s_cmp_eq_u32 s3, 1
  s_cbranch_scc0 L_nopfs
  s_mov_b32 s40, s24
  s_mov_b32 s41, s25
  s_mov_b32 s42, 0x400000
  s_mov_b32 s43, 0x20000
  s_lshl_b32 s6, s5, 19
  s_lshl_b32 s7, s56, 15
  s_add_u32 s6, s6, s7
  v_lshlrev_b32 v10, 7, v0
  buffer_load_dword v240, v10, s[40:43], s6 offen
  s_add_u32 s6, s6, 8192
  buffer_load_dword v241, v10, s[40:43], s6 offen
  s_add_u32 s6, s6, 8192
  buffer_load_dword v242, v10, s[40:43], s6 offen
  s_add_u32 s6, s6, 8192
  buffer_load_dword v243, v10, s[40:43], s6 offen
L_nopfs:
  s_waitcnt vmcnt(0) lgkmcnt(0)
  s_mul_i32 s63, s63, 1664525
  s_add_u32 s63, s63, 1013904223
  s_branch L_Tbar
L_pf:
  s_cmp_lg_u32 s48, 7
  s_cbranch_scc1 L_nopf3
  s_getpc_b64 s[6:7]
L_pc:
  s_sub_u32 s6, s6, L_pc-sequential_preLN__mha_block_cached__swiglu_ffn__decode_kernel
  s_subb_u32 s7, s7, 0
  v_lshlrev_b32 v6, 7, v0
  v_cmp_gt_u32 vcc, L_codeend-sequential_preLN__mha_block_cached__swiglu_ffn__decode_kernel, v6
  s_and_b64 exec, vcc, vcc
  global_load_dword v60, v6, s[6:7]
  s_mov_b64 exec, -1
  v_add_u32 v6, 0x2000, v6
  v_cmp_gt_u32 vcc, L_codeend-sequential_preLN__mha_block_cached__swiglu_ffn__decode_kernel, v6
  s_and_b64 exec, vcc, vcc
  s_cbranch_execz L_nopf2
  global_load_dword v61, v6, s[6:7]
L_nopf2:
  s_mov_b64 exec, -1
L_nopf3:
  s_waitcnt lgkmcnt(0)
  s_load_dword s63, s[38:39], 16384
  v_mov_b32 v28, -1
  v_mov_b32 v29, -1
  v_mov_b32 v30, -1
  v_mov_b32 v31, -1
  s_add_u32 s44, s38, 0x2000
  s_addc_u32 s45, s39, 0
  s_lshl_b32 s54, s4, 14
  s_lshl_b32 s6, s5, 10
  s_add_u32 s6, s6, s54
  s_add_u32 s6, s6, 524288
  v_add_u32 v13, s6, v5
  s_cmp_lt_u32 s48, 7
  s_cbranch_scc0 L_nozc
  s_lshr_b32 s6, s49, 2
  s_lshl_b32 s6, s6, 14
  s_and_b32 s7, s49, 3
  s_lshl_b32 s7, s7, 11
  s_add_u32 s6, s6, s7
  s_add_u32 s6, s6, 1572864
  v_add_u32 v14, s6, v5
  global_store_dwordx4 v14, v[28:31], s[38:39] sc1
  global_store_dwordx4 v14, v[28:31], s[44:45] sc1
  global_store_dwordx4 v14, v[28:31], s[38:39] offset:1024 sc1
  global_store_dwordx4 v14, v[28:31], s[44:45] offset:1024 sc1
L_nozc:
  s_lshr_b32 s6, s48, 3
  s_cmp_eq_u32 s6, 2
  s_cbranch_scc0 L_noyc
  s_lshr_b32 s6, s5, 1
  s_lshl_b32 s6, s6, 14
  s_and_b32 s7, s5, 1
  s_lshl_b32 s7, s7, 12
  s_add_u32 s6, s6, s7
  s_and_b32 s7, s48, 7
  s_lshl_b32 s7, s7, 9
  s_add_u32 s6, s6, s7
  s_add_u32 s6, s6, 65536
  v_add_u32 v14, s6, v5
  s_mov_b32 exec_hi, 0
  global_store_dwordx4 v14, v[28:31], s[38:39] sc1
  global_store_dwordx4 v14, v[28:31], s[44:45] sc1
L_noyc:
  s_mov_b64 exec, 1
  s_lshl_b32 s6, s2, 7
  s_add_u32 s6, s6, 32768
  v_mov_b32 v14, s6
  s_waitcnt vmcnt(0) lgkmcnt(0)
  s_mul_i32 s63, s63, 1664525
  s_add_u32 s63, s63, 1013904223
  v_mov_b32 v15, 0
  v_mov_b32 v14, 320
  ds_write_b32 v14, v15
  s_mov_b64 exec, -1
  s_branch L_Tbar
L_q:
  v_mov_b32 v16, 256
  ds_write_b64 v16, v[18:19]
  ds_write_b64 v16, v[18:19] offset:8
  ds_write_b64 v16, v[18:19] offset:32
  v_lshlrev_b32 v21, 2, v0
  s_add_u32 s6, s5, 1
  v_mov_b32 v22, 0
  ds_write_b32 v16, v18 offset:48
  ds_write_b32 v21, v22 offset:512
  s_mul_i32 s49, s5, 7
  s_add_u32 s49, s49, s48
  v_and_b32 v61, 1, v4
  v_lshlrev_b32 v61, 4, v61
  v_mov_b32 v60, 0xffff
  v_lshlrev_b32 v61, v61, v60
  v_lshrrev_b32 v60, 1, v4
  v_cmp_eq_u32 vcc, 0, v60
  s_nop 1
  v_cndmask_b32 v24, 0, v61, vcc
  v_cmp_eq_u32 vcc, 1, v60
  s_nop 1
  v_cndmask_b32 v25, 0, v61, vcc
  v_cmp_eq_u32 vcc, 2, v60
  s_nop 1
  v_cndmask_b32 v26, 0, v61, vcc
  v_cmp_eq_u32 vcc, 3, v60
  s_nop 1
  v_cndmask_b32 v27, 0, v61, vcc
  s_waitcnt vmcnt(16)
  v_lshlrev_b32 v32, 16, v8
  v_and_b32 v33, s61, v8
  v_lshlrev_b32 v34, 16, v9
  v_and_b32 v35, s61, v9
  v_lshlrev_b32 v36, 16, v10
  v_and_b32 v37, s61, v10
  v_lshlrev_b32 v38, 16, v11
  v_and_b32 v39, s61, v11
  v_add_f32 v40, v32, v33
  v_add_f32 v41, v34, v35
  v_add_f32 v42, v36, v37
  v_add_f32 v43, v38, v39
  v_add_f32 v40, v40, v41
  v_add_f32 v42, v42, v43
  v_add_f32 v40, v40, v42
  s_nop 1
  v_add_f32_dpp v40, v40, v40 row_ror:1 row_mask:0xf bank_mask:0xf
  s_nop 1
  v_add_f32_dpp v40, v40, v40 row_ror:2 row_mask:0xf bank_mask:0xf
  s_nop 1
  v_add_f32_dpp v40, v40, v40 row_ror:4 row_mask:0xf bank_mask:0xf
  s_nop 1
  v_add_f32_dpp v40, v40, v40 row_ror:8 row_mask:0xf bank_mask:0xf
  v_mov_b32 v42, v40
  s_nop 1
  v_permlane16_swap_b32 v42, v40
  s_nop 0
  v_add_f32 v40, v40, v42
  v_mov_b32 v42, v40
  s_nop 1
  v_permlane32_swap_b32 v42, v40
  s_nop 0
  v_add_f32 v40, v40, v42
  v_mul_f32 v40, 0x3b000000, v40
  v_sub_f32 v42, v32, v40
  v_sub_f32 v43, v33, v40
  v_mul_f32 v41, v42, v42
  v_fmac_f32 v41, v43, v43
  v_sub_f32 v42, v34, v40
  v_sub_f32 v43, v35, v40
  v_fmac_f32 v41, v42, v42
  v_fmac_f32 v41, v43, v43
  v_sub_f32 v42, v36, v40
  v_sub_f32 v43, v37, v40
  v_fmac_f32 v41, v42, v42
  v_fmac_f32 v41, v43, v43
  v_sub_f32 v42, v38, v40
  v_sub_f32 v43, v39, v40
  v_fmac_f32 v41, v42, v42
  v_fmac_f32 v41, v43, v43
  v_cvt_pk_bf16_f32 v40, v40, v40
  v_and_b32 v40, s61, v40
  v_add_f32_dpp v41, v41, v41 row_ror:1 row_mask:0xf bank_mask:0xf
  s_nop 1
  v_add_f32_dpp v41, v41, v41 row_ror:2 row_mask:0xf bank_mask:0xf
  s_nop 1
  v_add_f32_dpp v41, v41, v41 row_ror:4 row_mask:0xf bank_mask:0xf
  s_nop 1
  v_add_f32_dpp v41, v41, v41 row_ror:8 row_mask:0xf bank_mask:0xf
  v_mov_b32 v42, v41
  s_nop 1
  v_permlane16_swap_b32 v42, v41
  s_nop 0
  v_add_f32 v41, v41, v42
  v_mov_b32 v42, v41
  s_nop 1
  v_permlane32_swap_b32 v42, v41
  s_nop 0
  v_add_f32 v41, v41, v42
  v_mul_f32 v41, 0x3b000000, v41
  v_cvt_pk_bf16_f32 v41, v41, v41
  v_and_b32 v41, s61, v41
  v_add_f32 v41, 0x3727c5ac, v41
  v_cvt_pk_bf16_f32 v41, v41, v41
  v_and_b32 v41, s61, v41
  v_sqrt_f32 v41, v41
  s_nop 0
  v_cvt_pk_bf16_f32 v41, v41, v41
  v_and_b32 v41, s61, v41
  v_rcp_f32 v41, v41
  s_nop 0
  v_lshlrev_b32 v12, 16, v12
  v_sub_f32 v12, v12, v40
  v_cvt_pk_bf16_f32 v12, v12, v12
  v_and_b32 v12, s61, v12
  v_mul_f32 v12, v12, v41
  v_cvt_pk_bf16_f32 v12, v12, v12
  s_nop 0
  s_waitcnt vmcnt(0) lgkmcnt(0)
  v_and_b32_dpp v44, v12, v24 row_newbcast:0 row_mask:0xf bank_mask:0xf
  v_and_b32_dpp v45, v12, v25 row_newbcast:0 row_mask:0xf bank_mask:0xf
  v_and_b32_dpp v46, v12, v26 row_newbcast:0 row_mask:0xf bank_mask:0xf
  v_and_b32_dpp v47, v12, v27 row_newbcast:0 row_mask:0xf bank_mask:0xf
  v_and_b32_dpp v48, v12, v24 row_newbcast:1 row_mask:0xf bank_mask:0xf
  v_and_b32_dpp v49, v12, v25 row_newbcast:1 row_mask:0xf bank_mask:0xf
  v_and_b32_dpp v50, v12, v26 row_newbcast:1 row_mask:0xf bank_mask:0xf
  v_and_b32_dpp v51, v12, v27 row_newbcast:1 row_mask:0xf bank_mask:0xf
  v_mfma_f32_16x16x32_bf16 v[52:55], v[44:47], v[64:67], 0
  v_and_b32_dpp v44, v12, v24 row_newbcast:2 row_mask:0xf bank_mask:0xf
  v_and_b32_dpp v45, v12, v25 row_newbcast:2 row_mask:0xf bank_mask:0xf
  v_and_b32_dpp v46, v12, v26 row_newbcast:2 row_mask:0xf bank_mask:0xf
  v_and_b32_dpp v47, v12, v27 row_newbcast:2 row_mask:0xf bank_mask:0xf
  v_mfma_f32_16x16x32_bf16 v[52:55], v[48:51], v[68:71], v[52:55]
  v_and_b32_dpp v48, v12, v24 row_newbcast:3 row_mask:0xf bank_mask:0xf
  v_and_b32_dpp v49, v12, v25 row_newbcast:3 row_mask:0xf bank_mask:0xf
  v_and_b32_dpp v50, v12, v26 row_newbcast:3 row_mask:0xf bank_mask:0xf
  v_and_b32_dpp v51, v12, v27 row_newbcast:3 row_mask:0xf bank_mask:0xf
  v_mfma_f32_16x16x32_bf16 v[52:55], v[44:47], v[72:75], v[52:55]
  v_and_b32_dpp v44, v12, v24 row_newbcast:4 row_mask:0xf bank_mask:0xf
  v_and_b32_dpp v45, v12, v25 row_newbcast:4 row_mask:0xf bank_mask:0xf
  v_and_b32_dpp v46, v12, v26 row_newbcast:4 row_mask:0xf bank_mask:0xf
  v_and_b32_dpp v47, v12, v27 row_newbcast:4 row_mask:0xf bank_mask:0xf
  v_mfma_f32_16x16x32_bf16 v[52:55], v[48:51], v[76:79], v[52:55]
  v_and_b32_dpp v48, v12, v24 row_newbcast:5 row_mask:0xf bank_mask:0xf
  v_and_b32_dpp v49, v12, v25 row_newbcast:5 row_mask:0xf bank_mask:0xf
  v_and_b32_dpp v50, v12, v26 row_newbcast:5 row_mask:0xf bank_mask:0xf
  v_and_b32_dpp v51, v12, v27 row_newbcast:5 row_mask:0xf bank_mask:0xf
  v_mfma_f32_16x16x32_bf16 v[52:55], v[44:47], v[80:83], v[52:55]
  v_and_b32_dpp v44, v12, v24 row_newbcast:6 row_mask:0xf bank_mask:0xf
  v_and_b32_dpp v45, v12, v25 row_newbcast:6 row_mask:0xf bank_mask:0xf
  v_and_b32_dpp v46, v12, v26 row_newbcast:6 row_mask:0xf bank_mask:0xf
  v_and_b32_dpp v47, v12, v27 row_newbcast:6 row_mask:0xf bank_mask:0xf
  v_mfma_f32_16x16x32_bf16 v[52:55], v[48:51], v[84:87], v[52:55]
  v_and_b32_dpp v48, v12, v24 row_newbcast:7 row_mask:0xf bank_mask:0xf
  v_and_b32_dpp v49, v12, v25 row_newbcast:7 row_mask:0xf bank_mask:0xf
  v_and_b32_dpp v50, v12, v26 row_newbcast:7 row_mask:0xf bank_mask:0xf
  v_and_b32_dpp v51, v12, v27 row_newbcast:7 row_mask:0xf bank_mask:0xf
  v_mfma_f32_16x16x32_bf16 v[52:55], v[44:47], v[88:91], v[52:55]
  v_and_b32_dpp v44, v12, v24 row_newbcast:8 row_mask:0xf bank_mask:0xf
  v_and_b32_dpp v45, v12, v25 row_newbcast:8 row_mask:0xf bank_mask:0xf
  v_and_b32_dpp v46, v12, v26 row_newbcast:8 row_mask:0xf bank_mask:0xf
  v_and_b32_dpp v47, v12, v27 row_newbcast:8 row_mask:0xf bank_mask:0xf
  v_mfma_f32_16x16x32_bf16 v[52:55], v[48:51], v[92:95], v[52:55]
  v_and_b32_dpp v48, v12, v24 row_newbcast:9 row_mask:0xf bank_mask:0xf
  v_and_b32_dpp v49, v12, v25 row_newbcast:9 row_mask:0xf bank_mask:0xf
  v_and_b32_dpp v50, v12, v26 row_newbcast:9 row_mask:0xf bank_mask:0xf
  v_and_b32_dpp v51, v12, v27 row_newbcast:9 row_mask:0xf bank_mask:0xf
  v_mfma_f32_16x16x32_bf16 v[52:55], v[44:47], v[96:99], v[52:55]
  v_and_b32_dpp v44, v12, v24 row_newbcast:10 row_mask:0xf bank_mask:0xf
  v_and_b32_dpp v45, v12, v25 row_newbcast:10 row_mask:0xf bank_mask:0xf
  v_and_b32_dpp v46, v12, v26 row_newbcast:10 row_mask:0xf bank_mask:0xf
  v_and_b32_dpp v47, v12, v27 row_newbcast:10 row_mask:0xf bank_mask:0xf
  v_mfma_f32_16x16x32_bf16 v[52:55], v[48:51], v[100:103], v[52:55]
  v_and_b32_dpp v48, v12, v24 row_newbcast:11 row_mask:0xf bank_mask:0xf
  v_and_b32_dpp v49, v12, v25 row_newbcast:11 row_mask:0xf bank_mask:0xf
  v_and_b32_dpp v50, v12, v26 row_newbcast:11 row_mask:0xf bank_mask:0xf
  v_and_b32_dpp v51, v12, v27 row_newbcast:11 row_mask:0xf bank_mask:0xf
  v_mfma_f32_16x16x32_bf16 v[52:55], v[44:47], v[104:107], v[52:55]
  v_and_b32_dpp v44, v12, v24 row_newbcast:12 row_mask:0xf bank_mask:0xf
  v_and_b32_dpp v45, v12, v25 row_newbcast:12 row_mask:0xf bank_mask:0xf
  v_and_b32_dpp v46, v12, v26 row_newbcast:12 row_mask:0xf bank_mask:0xf
  v_and_b32_dpp v47, v12, v27 row_newbcast:12 row_mask:0xf bank_mask:0xf
  v_mfma_f32_16x16x32_bf16 v[52:55], v[48:51], v[108:111], v[52:55]
  v_and_b32_dpp v48, v12, v24 row_newbcast:13 row_mask:0xf bank_mask:0xf
  v_and_b32_dpp v49, v12, v25 row_newbcast:13 row_mask:0xf bank_mask:0xf
  v_and_b32_dpp v50, v12, v26 row_newbcast:13 row_mask:0xf bank_mask:0xf
  v_and_b32_dpp v51, v12, v27 row_newbcast:13 row_mask:0xf bank_mask:0xf
  v_mfma_f32_16x16x32_bf16 v[52:55], v[44:47], v[112:115], v[52:55]
  v_and_b32_dpp v44, v12, v24 row_newbcast:14 row_mask:0xf bank_mask:0xf
  v_and_b32_dpp v45, v12, v25 row_newbcast:14 row_mask:0xf bank_mask:0xf
  v_and_b32_dpp v46, v12, v26 row_newbcast:14 row_mask:0xf bank_mask:0xf
  v_and_b32_dpp v47, v12, v27 row_newbcast:14 row_mask:0xf bank_mask:0xf
  v_mfma_f32_16x16x32_bf16 v[52:55], v[48:51], v[116:119], v[52:55]
  v_and_b32_dpp v48, v12, v24 row_newbcast:15 row_mask:0xf bank_mask:0xf
  v_and_b32_dpp v49, v12, v25 row_newbcast:15 row_mask:0xf bank_mask:0xf
  v_and_b32_dpp v50, v12, v26 row_newbcast:15 row_mask:0xf bank_mask:0xf
  v_and_b32_dpp v51, v12, v27 row_newbcast:15 row_mask:0xf bank_mask:0xf
  v_mfma_f32_16x16x32_bf16 v[52:55], v[44:47], v[120:123], v[52:55]
  s_mul_i32 s63, s63, 1664525
  s_add_u32 s63, s63, 1013904223
  v_mfma_f32_16x16x32_bf16 v[52:55], v[48:51], v[124:127], v[52:55]
  s_lshl_b32 s6, s2, 9
  s_add_u32 s6, s6, 262144
  v_and_b32 v14, 1, v3
  v_lshrrev_b32 v15, 1, v3
  v_lshlrev_b32 v20, 4, v4
  v_lshl_add_u32 v20, v14, 3, v20
  v_lshl_add_u32 v20, v15, 2, v20
  v_add_u32 v13, s6, v5
  s_mov_b32 exec_hi, 0
  global_store_dwordx4 v13, v[52:55], s[38:39] sc1
  s_mov_b64 exec, -1
  s_lshl_b32 s6, s4, 12
  s_add_u32 s6, s6, 262144
  v_add_u32 v13, s6, v5
  s_lshl_b32 s6, s4, 10
  s_add_u32 s6, s6, 196608
  s_add_u32 s8, s38, s6
  s_addc_u32 s9, s39, 0
  s_lshl_b32 s7, s5, 7
  s_mov_b32 s10, s63
  v_mov_b32 v14, s7
  v_mov_b32 v15, s63
  v_mov_b32 v16, 320
L_qcl:
  ds_read_b32 v17, v16
  s_sub_u32 s60, s60, 1
  s_cbranch_scc1 L_abort
  s_waitcnt lgkmcnt(0)
  v_cmp_ne_u32 vcc, 0, v17
  s_cbranch_vccnz L_qcl
  s_waitcnt vmcnt(0)
  s_mov_b64 exec, 1
  global_store_dword v14, v15, s[8:9] sc1
  s_mov_b64 exec, -1
L_qsp:
  s_sleep 4
  s_load_dword s84, s[8:9], 0 glc
  s_load_dword s85, s[8:9], 128 glc
  s_load_dword s86, s[8:9], 256 glc
  s_load_dword s87, s[8:9], 384 glc
  s_load_dword s88, s[8:9], 512 glc
  s_load_dword s89, s[8:9], 640 glc
  s_load_dword s90, s[8:9], 768 glc
  s_load_dword s91, s[8:9], 896 glc
  s_sub_u32 s60, s60, 1
  s_cbranch_scc1 L_abort
  s_waitcnt lgkmcnt(0)
  s_xor_b32 s84, s84, s63
  s_xor_b32 s85, s85, s63
  s_xor_b32 s86, s86, s63
  s_xor_b32 s87, s87, s63
  s_xor_b32 s88, s88, s63
  s_xor_b32 s89, s89, s63
  s_xor_b32 s90, s90, s63
  s_xor_b32 s91, s91, s63
  s_or_b32 s84, s84, s85
  s_or_b32 s84, s84, s86
  s_or_b32 s84, s84, s87
  s_or_b32 s84, s84, s88
  s_or_b32 s84, s84, s89
  s_or_b32 s84, s84, s90
  s_or_b32 s84, s84, s91
  s_cbranch_scc1 L_qsp
  global_load_dwordx4 v[64:67], v13, s[38:39] offset:0 sc1
  global_load_dwordx4 v[68:71], v13, s[38:39] offset:1024 sc1
  global_load_dwordx4 v[72:75], v13, s[38:39] offset:2048 sc1
  global_load_dwordx4 v[76:79], v13, s[38:39] offset:3072 sc1
  s_waitcnt vmcnt(0)
  v_pk_add_f32 v[64:65], v[64:65], v[68:69]
  v_pk_add_f32 v[66:67], v[66:67], v[70:71]
  v_pk_add_f32 v[72:73], v[72:73], v[76:77]
  v_pk_add_f32 v[74:75], v[74:75], v[78:79]
  v_pk_add_f32 v[64:65], v[64:65], v[72:73]
  v_pk_add_f32 v[66:67], v[66:67], v[74:75]
  s_nop 1
  v_permlane32_swap_b32 v64, v66
  v_permlane32_swap_b32 v65, v67
  s_nop 0
  v_pk_add_f32 v[64:65], v[64:65], v[66:67]
  v_cvt_pk_bf16_f32 v32, v64, v65
  ds_write_b32 v20, v32 offset:0
  s_waitcnt lgkmcnt(0)
L_Tbar:
  s_barrier
  s_bitcmp1_b32 s48, 3
  s_cbranch_scc0 L_nohelp
  s_cmp_eq_u32 s3, 1
  s_cbranch_scc0 L_nohelp
  s_and_b32 s56, s48, 7
  s_lshr_b32 s57, s48, 4
  s_lshl_b32 s57, s57, 3
  s_add_u32 s56, s56, s57
  v_lshrrev_b32 v10, 2, v0
  v_mul_u32_u24 v10, 3584, v10
  v_and_b32 v11, 3, v0
  v_lshl_add_u32 v10, v11, 7, v10
  s_mul_i32 s6, s5, 448
  s_andn2_b32 s6, s6, 127
  s_mul_i32 s7, s56, 114688
  s_add_u32 s6, s6, s7
  v_add_u32 v10, s6, v10
  v_add_u32 v11, 57344, v10
  s_mul_i32 s6, s5, 229376
  s_mul_i32 s7, s56, 14336
  s_add_u32 s6, s6, s7
  v_lshl_add_u32 v12, v0, 7, s6
  v_add_u32 v13, 7168, v12
  s_barrier
  global_load_dword v244, v10, s[28:29]
  global_load_dword v245, v11, s[28:29]
  global_load_dword v246, v10, s[30:31]
  global_load_dword v247, v11, s[30:31]
  s_mov_b32 exec_hi, 0x00ffffff
  global_load_dword v248, v12, s[32:33]
  global_load_dword v249, v13, s[32:33]
  s_waitcnt vmcnt(0)
  s_endpgm
L_nohelp:
  s_mov_b32 s59, 0x3fb8aa3b
  s_mov_b32 s55, s3
  v_bfe_u32 v12, v0, 2, 2
  v_lshl_add_u32 v13, v3, 3, v12
  v_and_b32 v12, 3, v0
  v_lshlrev_b32 v17, 4, v3
  s_cmp_lt_u32 s48, 7
  s_cbranch_scc1 L_F
  s_lshr_b32 s6, s48, 2
  s_cmp_eq_u32 s6, 2
  s_cbranch_scc1 L_R
  s_lshr_b32 s6, s48, 3
  s_cmp_eq_u32 s6, 2
  s_cbranch_scc0 L_norole
  s_mov_b32 s40, s24
  s_mov_b32 s41, s25
  s_mov_b32 s42, 0x400000
  s_mov_b32 s43, 0x20000
  s_lshl_b32 s6, s5, 19
  s_and_b32 s7, s48, 7
  s_lshl_b32 s7, s7, 7
  s_add_u32 s6, s6, s7
  s_mul_i32 s7, s55, 131072
  s_add_u32 s6, s6, s7
  v_lshrrev_b32 v10, 3, v0
  v_lshlrev_b32 v10, 10, v10
  v_and_b32 v11, 7, v0
  v_lshl_add_u32 v10, v11, 4, v10
  s_mul_i32 s7, s55, 16384
  s_add_u32 s7, s7, 8192
  s_mov_b32 s54, 16
L_dmaW:
  s_mov_b32 m0, s7
  s_add_u32 s7, s7, 1024
  buffer_load_dwordx4 v10, s[40:43], s6 offen  lds
  s_add_u32 s6, s6, 8192
  s_sub_u32 s54, s54, 1
  s_cmp_lg_u32 s54, 0
  s_cbranch_scc1 L_dmaW
  s_waitcnt vmcnt(0)
  v_mov_b32 v10, 260
  v_mov_b32 v11, 1
  s_mov_b64 exec, 1
  ds_add_u32 v10, v11
  s_mov_b64 exec, -1
  v_mov_b32 v10, 260
L_wsync:
  s_sleep 2
  ds_read_b32 v28, v10
  s_sub_u32 s60, s60, 1
  s_cbranch_scc1 L_abort
  s_waitcnt lgkmcnt(0)
  v_cmp_ne_u32 vcc, 4, v28
  s_cbranch_vccnz L_wsync
  v_lshlrev_b32 v15, 7, v13
  v_lshl_add_u32 v15, v12, 3, v15
  s_lshl_b32 s7, s3, 5
  s_add_u32 s7, s7, 8192
  v_add_u32 v15, s7, v15
  ds_read_b64_tr_b16 v[64:65], v15 offset:0
  ds_read_b64_tr_b16 v[66:67], v15 offset:512
  ds_read_b64_tr_b16 v[68:69], v15 offset:4096
  ds_read_b64_tr_b16 v[70:71], v15 offset:4608
  ds_read_b64_tr_b16 v[72:73], v15 offset:8192
  ds_read_b64_tr_b16 v[74:75], v15 offset:8704
  ds_read_b64_tr_b16 v[76:77], v15 offset:12288
  ds_read_b64_tr_b16 v[78:79], v15 offset:12800
  ds_read_b64_tr_b16 v[80:81], v15 offset:16384
  ds_read_b64_tr_b16 v[82:83], v15 offset:16896
  ds_read_b64_tr_b16 v[84:85], v15 offset:20480
  ds_read_b64_tr_b16 v[86:87], v15 offset:20992
  ds_read_b64_tr_b16 v[88:89], v15 offset:24576
  ds_read_b64_tr_b16 v[90:91], v15 offset:25088
  ds_read_b64_tr_b16 v[92:93], v15 offset:28672
  ds_read_b64_tr_b16 v[94:95], v15 offset:29184
  ds_read_b64_tr_b16 v[96:97], v15 offset:32768
  ds_read_b64_tr_b16 v[98:99], v15 offset:33280
  ds_read_b64_tr_b16 v[100:101], v15 offset:36864
  ds_read_b64_tr_b16 v[102:103], v15 offset:37376
  ds_read_b64_tr_b16 v[104:105], v15 offset:40960
  ds_read_b64_tr_b16 v[106:107], v15 offset:41472
  ds_read_b64_tr_b16 v[108:109], v15 offset:45056
  ds_read_b64_tr_b16 v[110:111], v15 offset:45568
  ds_read_b64_tr_b16 v[112:113], v15 offset:49152
  ds_read_b64_tr_b16 v[114:115], v15 offset:49664
  ds_read_b64_tr_b16 v[116:117], v15 offset:53248
  ds_read_b64_tr_b16 v[118:119], v15 offset:53760
  ds_read_b64_tr_b16 v[120:121], v15 offset:57344
  ds_read_b64_tr_b16 v[122:123], v15 offset:57856
  ds_read_b64_tr_b16 v[124:125], v15 offset:61440
  ds_read_b64_tr_b16 v[126:127], v15 offset:61952
  v_and_b32 v61, 1, v4
  v_lshlrev_b32 v61, 4, v61
  v_mov_b32 v60, 0xffff
  v_lshlrev_b32 v61, v61, v60
  v_lshrrev_b32 v60, 1, v4
  v_cmp_eq_u32 vcc, 0, v60
  s_nop 1
  v_cndmask_b32 v24, 0, v61, vcc
  v_cmp_eq_u32 vcc, 1, v60
  s_nop 1
  v_cndmask_b32 v25, 0, v61, vcc
  v_cmp_eq_u32 vcc, 2, v60
  s_nop 1
  v_cndmask_b32 v26, 0, v61, vcc
  v_cmp_eq_u32 vcc, 3, v60
  s_nop 1
  v_cndmask_b32 v27, 0, v61, vcc
  s_lshl_b32 s6, s5, 2
  s_add_u32 s6, s6, s3
  v_and_b32 v13, 7, v0
  s_lshl_b32 s7, s6, 3
  v_add_u32 v10, s7, v13
  v_and_b32 v24, 0x3f803f80, v24
  v_and_b32 v25, 0x3f803f80, v25
  v_and_b32 v26, 0x3f803f80, v26
  v_and_b32 v27, 0x3f803f80, v27
  s_lshl_b32 s7, s6, 14
  s_add_u32 s7, s7, 528384
  v_add_u32 v14, s7, v5
  s_lshl_b32 s7, s3, 8
  v_lshl_add_u32 v23, v4, 1, v3
  v_and_b32 v23, 15, v23
  v_lshl_add_u32 v23, v23, 4, s7
  v_lshrrev_b32 v11, 3, v4
  v_lshl_add_u32 v23, v11, 3, v23
  s_lshr_b32 s6, s5, 1
  s_lshl_b32 s6, s6, 14
  s_and_b32 s7, s5, 1
  s_lshl_b32 s7, s7, 12
  s_add_u32 s6, s6, s7
  s_and_b32 s7, s48, 7
  s_lshl_b32 s7, s7, 9
  s_add_u32 s6, s6, s7
  s_add_u32 s6, s6, 65536
  s_lshl_b32 s7, s3, 7
  s_add_u32 s6, s6, s7
  v_lshl_add_u32 v7, v0, 2, s6
  s_getpc_b64 s[6:7]
L_pcw:
  s_add_u32 s6, s6, L_wexit-L_pcw
  s_addc_u32 s7, s7, 0
  v_lshlrev_b32 v28, 7, v0
  s_mov_b64 exec, 31
  global_load_dword v250, v28, s[6:7]
  s_mov_b64 exec, -1
  s_mov_b64 exec, 0xff
  v_lshlrev_b32 v10, 7, v10
  v_add_u32 v10, 196608, v10
L_wclr:
  global_load_dword v28, v10, s[38:39] sc1
  s_sub_u32 s60, s60, 1
  s_cbranch_scc1 L_abort
  s_waitcnt vmcnt(0)
  v_cmp_ne_u32 vcc, s63, v28
  s_cbranch_vccnz L_wclr
  s_mov_b64 exec, -1
  s_cmp_lg_u32 s3, 3
  s_cbranch_scc1 L_wcal_j
  s_call_b64 s[92:93], L_scjob
L_wcal_j:
  s_add_u32 s44, s38, 0x2000
  s_addc_u32 s45, s39, 0
  s_lshl_b32 s6, s2, 2
  s_add_u32 s6, s6, s3
  s_lshr_b32 s7, s6, 6
  s_lshl_b32 s7, s7, 14
  s_and_b32 s6, s6, 63
  s_lshl_b32 s6, s6, 7
  s_add_u32 s6, s6, s7
  s_add_u32 s6, s6, 1835008
  s_mov_b32 s56, -1
  s_mov_b32 s57, -1
  s_memtime s[12:13]
  v_mov_b32 v10, 264
L_wcal:
  s_memtime s[8:9]
  s_waitcnt lgkmcnt(0)
  s_load_dword s7, s[38:39], s6 glc
  s_waitcnt lgkmcnt(0)
  s_memtime s[10:11]
  s_waitcnt lgkmcnt(0)
  s_sub_u32 s7, s10, s8
  s_min_u32 s56, s56, s7
  s_memtime s[8:9]
  s_waitcnt lgkmcnt(0)
  s_load_dword s7, s[44:45], s6 glc
  s_waitcnt lgkmcnt(0)
  s_memtime s[10:11]
  s_waitcnt lgkmcnt(0)
  s_sub_u32 s7, s10, s8
  s_min_u32 s57, s57, s7
  ds_read_b32 v28, v10
  s_min_u32 s7, s56, s57
  s_cmp_lt_u32 s7, 540
  s_cbranch_scc1 L_wcal_c
  s_waitcnt lgkmcnt(0)
  v_readfirstlane_b32 s14, v28
  s_cmp_lg_u32 s14, 0
  s_cbranch_scc1 L_wcal_s
  s_sub_u32 s7, s10, s12
  s_cmp_lt_u32 s7, 30000
  s_cbranch_scc1 L_wcal
L_wcal_c:
  s_cmp_lt_u32 s57, s56
  s_cselect_b32 s14, 2, 1
  v_mov_b32 v29, s14
  ds_write_b32 v10, v29
L_wcal_s:
  s_cmp_eq_u32 s14, 2
  s_cselect_b32 s6, 0x2000, 0
L_wcal_d:
  s_waitcnt lgkmcnt(0)
  s_add_u32 s46, s38, s6
  s_addc_u32 s47, s39, 0
  s_xor_b32 s6, s6, 0x2000
  s_add_u32 s44, s38, s6
  s_addc_u32 s45, s39, 0
  s_cmp_lg_u32 s3, 3
  s_cbranch_scc1 L_wag
  s_call_b64 s[92:93], L_agent
L_wag:
  v_mov_b32 v128, -1
  v_mov_b32 v129, -1
  v_mov_b32 v130, -1
  v_mov_b32 v131, -1
  v_mov_b32 v132, -1
  v_mov_b32 v133, -1
  v_mov_b32 v134, -1
  v_mov_b32 v135, -1
  s_mov_b64 s[84:85], -1
  s_mov_b64 s[86:87], -1
L_wexit:
  s_barrier
L_pop:
  s_mov_b64 exec, s[84:85]
  global_load_dwordx4 v[128:131], v14, s[46:47] offset:-4096 sc1
  s_mov_b64 exec, s[86:87]
  global_load_dwordx4 v[132:135], v14, s[46:47] offset:-3072 sc1
  s_mov_b64 exec, -1
  s_sub_u32 s60, s60, 1
  s_cbranch_scc1 L_abort
  s_waitcnt vmcnt(4)
  v_max3_u32 v36, v128, v129, v130
  v_max_u32 v36, v36, v131
  v_cmp_eq_u32 s[84:85], -1, v36
  v_mfma_f32_16x16x32_bf16 v[40:43], v[24:27], v[128:131], 0
  v_max3_u32 v37, v132, v133, v134
  v_max_u32 v37, v37, v135
  v_cmp_eq_u32 s[86:87], -1, v37
  v_mfma_f32_16x16x32_bf16 v[40:43], v[24:27], v[132:135], v[40:43]
  s_or_b64 vcc, s[84:85], s[86:87]
  s_cbranch_scc1 L_pop
  s_mov_b32 exec_hi, 0
  s_nop 4
  v_cvt_pk_bf16_f32 v40, v40, v41
  v_cvt_pk_bf16_f32 v41, v42, v43
  ds_write_b64 v23, v[40:41] offset:2048
  s_mov_b64 exec, -1
  s_waitcnt lgkmcnt(0)
  s_barrier
  ds_read_b128 v[160:163], v17 offset:2048
  ds_read_b128 v[164:167], v17 offset:2112
  ds_read_b128 v[168:171], v17 offset:2176
  ds_read_b128 v[172:175], v17 offset:2240
  ds_read_b128 v[176:179], v17 offset:2304
  s_waitcnt lgkmcnt(4)
  v_mfma_f32_16x16x32_bf16 v[40:43], v[160:163], v[64:67], 0
  ds_read_b128 v[180:183], v17 offset:2368
  s_waitcnt lgkmcnt(4)
  v_mfma_f32_16x16x32_bf16 v[40:43], v[164:167], v[68:71], v[40:43]
  ds_read_b128 v[184:187], v17 offset:2432
  s_waitcnt lgkmcnt(4)
  v_mfma_f32_16x16x32_bf16 v[40:43], v[168:171], v[72:75], v[40:43]
  ds_read_b128 v[188:191], v17 offset:2496
  s_waitcnt lgkmcnt(4)
  v_mfma_f32_16x16x32_bf16 v[40:43], v[172:175], v[76:79], v[40:43]
  ds_read_b128 v[192:195], v17 offset:2560
  s_waitcnt lgkmcnt(4)
  v_mfma_f32_16x16x32_bf16 v[40:43], v[176:179], v[80:83], v[40:43]
  ds_read_b128 v[196:199], v17 offset:2624
  s_waitcnt lgkmcnt(4)
  v_mfma_f32_16x16x32_bf16 v[40:43], v[180:183], v[84:87], v[40:43]
  ds_read_b128 v[200:203], v17 offset:2688
  s_waitcnt lgkmcnt(4)
  v_mfma_f32_16x16x32_bf16 v[40:43], v[184:187], v[88:91], v[40:43]
  ds_read_b128 v[204:207], v17 offset:2752
  s_waitcnt lgkmcnt(4)
  v_mfma_f32_16x16x32_bf16 v[40:43], v[188:191], v[92:95], v[40:43]
  ds_read_b128 v[208:211], v17 offset:2816
  s_waitcnt lgkmcnt(4)
  v_mfma_f32_16x16x32_bf16 v[40:43], v[192:195], v[96:99], v[40:43]
  ds_read_b128 v[212:215], v17 offset:2880
  s_waitcnt lgkmcnt(4)
  v_mfma_f32_16x16x32_bf16 v[40:43], v[196:199], v[100:103], v[40:43]
  ds_read_b128 v[216:219], v17 offset:2944
  s_waitcnt lgkmcnt(4)
  v_mfma_f32_16x16x32_bf16 v[40:43], v[200:203], v[104:107], v[40:43]
  ds_read_b128 v[220:223], v17 offset:3008
  s_waitcnt lgkmcnt(4)
  v_mfma_f32_16x16x32_bf16 v[40:43], v[204:207], v[108:111], v[40:43]
  s_waitcnt lgkmcnt(3)
  v_mfma_f32_16x16x32_bf16 v[40:43], v[208:211], v[112:115], v[40:43]
  s_waitcnt lgkmcnt(2)
  v_mfma_f32_16x16x32_bf16 v[40:43], v[212:215], v[116:119], v[40:43]
  s_waitcnt lgkmcnt(1)
  v_mfma_f32_16x16x32_bf16 v[40:43], v[216:219], v[120:123], v[40:43]
  s_waitcnt lgkmcnt(0)
  v_mfma_f32_16x16x32_bf16 v[40:43], v[220:223], v[124:127], v[40:43]
  s_mov_b64 exec, 0xffff
  s_nop 6
  v_min_u32 v40, -2, v40
  global_store_dword v7, v40, s[44:45] sc1
  global_store_dword v7, v40, s[46:47] sc1
L_Tfin:
  s_endpgm
L_F:
  v_and_b32 v6, 31, v0
  s_lshl_b32 s6, s3, 8
  v_lshl_add_u32 v6, v6, 3, s6
  v_lshrrev_b32 v8, 5, v0
  v_lshl_add_u32 v6, v8, 2, v6
  global_load_dword v8, v6, s[16:17]
  v_lshlrev_b32 v15, 6, v13
  v_and_b32 v13, 1, v12
  v_lshl_add_u32 v15, v13, 3, v15
  v_lshrrev_b32 v13, 1, v12
  v_lshl_add_u32 v15, v13, 15, v15
  v_and_b32 v14, 1, v3
  v_lshl_or_b32 v14, v13, 1, v14
  v_xor_b32 v14, s3, v14
  v_lshl_add_u32 v15, v14, 4, v15
  v_add_u32 v15, 8192, v15
  v_cmp_eq_u32 vcc, 1, v12
  v_add_u32 v14, 2112, v17
  s_nop 0
  v_cndmask_b32 v17, v17, v14, vcc
  v_and_b32 v61, 1, v4
  v_lshlrev_b32 v61, 4, v61
  v_mov_b32 v60, 0xffff
  v_lshlrev_b32 v61, v61, v60
  v_lshrrev_b32 v60, 1, v4
  v_cmp_eq_u32 vcc, 0, v60
  s_nop 1
  v_cndmask_b32 v24, 0, v61, vcc
  v_cmp_eq_u32 vcc, 1, v60
  s_nop 1
  v_cndmask_b32 v25, 0, v61, vcc
  v_cmp_eq_u32 vcc, 2, v60
  s_nop 1
  v_cndmask_b32 v26, 0, v61, vcc
  v_cmp_eq_u32 vcc, 3, v60
  s_nop 1
  v_cndmask_b32 v27, 0, v61, vcc
  v_lshrrev_b32 v16, 5, v0
  v_lshlrev_b32 v16, 15, v16
  v_bfe_u32 v22, v0, 2, 3
  v_lshl_add_u32 v16, v22, 7, v16
  v_lshl_add_u32 v16, v12, 4, v16
  s_lshl_b32 s7, s3, 10
  s_add_u32 s7, s7, 69632
  v_add_u32 v16, s7, v16
  v_add_u32 v22, 0x4000, v16
  v_bfe_u32 v20, v0, 2, 1
  v_lshlrev_b32 v20, 10, v20
  v_lshl_add_u32 v20, v12, 8, v20
  s_lshl_b32 s7, s3, 11
  s_add_u32 s7, s7, 77824
  v_add_u32 v20, s7, v20
  v_add_u32 v19, v3, v4
  v_and_b32 v19, 7, v19
  v_xor_b32 v18, 4, v19
  v_mad_u32_u24 v18, v18, 18, v20
  v_mad_u32_u24 v20, v19, 18, v20
  v_add_u32 v19, s7, v5
  v_mov_b32 v52, 0
  v_mov_b32 v53, 0
  v_mov_b32 v54, 0
  v_mov_b32 v55, 0
  ds_write_b128 v19, v[52:55]
  ds_write_b128 v19, v[52:55] offset:1024
  v_add_u32 v19, 77824, v5
  s_lshl_b32 s7, s3, 2
  v_add_u32 v23, s7, v5
  s_lshr_b32 s6, s49, 2
  s_lshl_b32 s6, s6, 14
  s_and_b32 s7, s49, 3
  s_lshl_b32 s7, s7, 11
  s_add_u32 s6, s6, s7
  s_add_u32 s6, s6, 1572864
  s_lshl_b32 s7, s3, 9
  s_add_u32 s6, s6, s7
  v_add_u32 v21, s6, v5
  v_mov_b32 v52, 0x3f803f80
  v_mov_b32 v53, 0x3f803f80
  v_mov_b32 v54, 0x3f803f80
  v_mov_b32 v55, 0x3f803f80
  ds_write_b128 v5, v[52:55] offset:3136
  v_and_b32 v10, 7, v0
  v_add_u32 v10, 16, v10
  v_lshrrev_b32 v11, 3, v0
  v_lshlrev_b32 v28, 2, v11
  v_sub_u32 v10, v10, v28
  v_and_b32 v10, 31, v10
  v_lshl_add_u32 v10, v10, 3, v11
  s_getpc_b64 s[6:7]
L_pcf:
  s_add_u32 s6, s6, L_dma28-L_pcf
  s_addc_u32 s7, s7, 0
  v_lshlrev_b32 v28, 7, v0
  s_mov_b64 exec, 32767
  global_load_dword v250, v28, s[6:7]
  s_mov_b64 exec, -1
  v_lshlrev_b32 v10, 7, v10
  v_add_u32 v10, 196608, v10
L_fclr:
  global_load_dword v28, v10, s[38:39] sc1
  s_sub_u32 s60, s60, 1
  s_cbranch_scc1 L_abort
  s_waitcnt vmcnt(0)
  v_cmp_ne_u32 vcc, s63, v28
  s_cbranch_vccnz L_fclr
  s_cmp_lg_u32 s3, 3
  s_cbranch_scc1 L_fcal_j
  s_call_b64 s[92:93], L_scjob
L_fcal_j:
  s_add_u32 s44, s38, 0x2000
  s_addc_u32 s45, s39, 0
  s_lshl_b32 s6, s2, 2
  s_add_u32 s6, s6, s3
  s_lshr_b32 s7, s6, 6
  s_lshl_b32 s7, s7, 14
  s_and_b32 s6, s6, 63
  s_lshl_b32 s6, s6, 7
  s_add_u32 s6, s6, s7
  s_add_u32 s6, s6, 1835008
  s_mov_b32 s56, -1
  s_mov_b32 s57, -1
  s_memtime s[12:13]
  v_mov_b32 v10, 264
L_fcal:
  s_memtime s[8:9]
  s_waitcnt lgkmcnt(0)
  s_load_dword s7, s[38:39], s6 glc
  s_waitcnt lgkmcnt(0)
  s_memtime s[10:11]
  s_waitcnt lgkmcnt(0)
  s_sub_u32 s7, s10, s8
  s_min_u32 s56, s56, s7
  s_memtime s[8:9]
  s_waitcnt lgkmcnt(0)
  s_load_dword s7, s[44:45], s6 glc
  s_waitcnt lgkmcnt(0)
  s_memtime s[10:11]
  s_waitcnt lgkmcnt(0)
  s_sub_u32 s7, s10, s8
  s_min_u32 s57, s57, s7
  ds_read_b32 v28, v10
  s_min_u32 s7, s56, s57
  s_cmp_lt_u32 s7, 540
  s_cbranch_scc1 L_fcal_c
  s_waitcnt lgkmcnt(0)
  v_readfirstlane_b32 s14, v28
  s_cmp_lg_u32 s14, 0
  s_cbranch_scc1 L_fcal_s
  s_sub_u32 s7, s10, s12
  s_cmp_lt_u32 s7, 30000
  s_cbranch_scc1 L_fcal
L_fcal_c:
  s_cmp_lt_u32 s57, s56
  s_cselect_b32 s14, 2, 1
  v_mov_b32 v29, s14
  ds_write_b32 v10, v29
L_fcal_s:
  s_cmp_eq_u32 s14, 2
  s_cselect_b32 s6, 0x2000, 0
L_fcal_d:
  s_waitcnt lgkmcnt(0)
  s_add_u32 s46, s38, s6
  s_addc_u32 s47, s39, 0
  s_xor_b32 s6, s6, 0x2000
  s_add_u32 s44, s38, s6
  s_addc_u32 s45, s39, 0
  s_cmp_lg_u32 s3, 3
  s_cbranch_scc1 L_fag
  s_call_b64 s[92:93], L_agent
L_fag:
  v_lshlrev_b32 v48, 16, v8
  v_and_b32 v49, s61, v8
  s_barrier
  v_lshrrev_b32 v10, 2, v0
  v_mul_u32_u24 v10, 3584, v10
  v_and_b32 v11, 3, v0
  v_lshrrev_b32 v28, 5, v0
  v_xor_b32 v11, v11, v28
  v_lshl_add_u32 v10, v11, 4, v10
  s_mov_b32 s42, 1835008
  s_mov_b32 s43, 0x20000
  s_mov_b32 s40, s28
  s_mov_b32 s41, s29
  s_mul_i32 s6, s55, 458752
  s_lshl_b32 s7, s49, 6
  s_add_u32 s6, s6, s7
  s_mul_i32 s7, s55, 8192
  s_add_u32 s7, s7, 8192
  s_mov_b32 s54, 8
L_dma28:
  s_mov_b32 m0, s7
  s_add_u32 s7, s7, 1024
  buffer_load_dwordx4 v10, s[40:43], s6 offen  lds
  s_add_u32 s6, s6, 57344
  s_sub_u32 s54, s54, 1
  s_cmp_lg_u32 s54, 0
  s_cbranch_scc1 L_dma28
  v_xor_b32 v10, 32, v10
  s_mov_b32 s40, s30
  s_mov_b32 s41, s31
  s_mul_i32 s6, s55, 458752
  s_lshl_b32 s7, s49, 6
  s_add_u32 s6, s6, s7
  s_mul_i32 s7, s55, 8192
  s_add_u32 s7, s7, 40960
  s_mov_b32 s54, 8
L_dma30:
  s_mov_b32 m0, s7
  s_add_u32 s7, s7, 1024
  buffer_load_dwordx4 v10, s[40:43], s6 offen  lds
  s_add_u32 s6, s6, 57344
  s_sub_u32 s54, s54, 1
  s_cmp_lg_u32 s54, 0
  s_cbranch_scc1 L_dma30
  s_mov_b32 s40, s32
  s_mov_b32 s41, s33
  s_mov_b32 s42, 1835008
  s_mov_b32 s43, 0x20000
  v_lshlrev_b32 v10, 4, v4
  v_lshl_add_u32 v10, v3, 10, v10
  s_lshl_b32 s52, s49, 15
  s_lshl_b32 s7, s3, 8
  s_add_u32 s52, s52, s7
  buffer_load_dwordx4 v[192:195], v10, s[40:43], s52 offen
  s_add_u32 s52, s52, 4096
  buffer_load_dwordx4 v[196:199], v10, s[40:43], s52 offen
  s_add_u32 s52, s52, 4096
  buffer_load_dwordx4 v[200:203], v10, s[40:43], s52 offen
  s_add_u32 s52, s52, 4096
  buffer_load_dwordx4 v[204:207], v10, s[40:43], s52 offen
  s_add_u32 s52, s52, 4096
  buffer_load_dwordx4 v[208:211], v10, s[40:43], s52 offen
  s_add_u32 s52, s52, 4096
  buffer_load_dwordx4 v[212:215], v10, s[40:43], s52 offen
  s_add_u32 s52, s52, 4096
  buffer_load_dwordx4 v[216:219], v10, s[40:43], s52 offen
  s_add_u32 s52, s52, 4096
  buffer_load_dwordx4 v[220:223], v10, s[40:43], s52 offen
  s_waitcnt vmcnt(8)
  s_barrier
  ds_read_b64_tr_b16 v[64:65], v15 offset:0
  ds_read_b64_tr_b16 v[66:67], v15 offset:256
  ds_read_b64_tr_b16 v[68:69], v15 offset:2048
  ds_read_b64_tr_b16 v[70:71], v15 offset:2304
  ds_read_b64_tr_b16 v[72:73], v15 offset:4096
  ds_read_b64_tr_b16 v[74:75], v15 offset:4352
  ds_read_b64_tr_b16 v[76:77], v15 offset:6144
  ds_read_b64_tr_b16 v[78:79], v15 offset:6400
  ds_read_b64_tr_b16 v[80:81], v15 offset:8192
  ds_read_b64_tr_b16 v[82:83], v15 offset:8448
  ds_read_b64_tr_b16 v[84:85], v15 offset:10240
  ds_read_b64_tr_b16 v[86:87], v15 offset:10496
  ds_read_b64_tr_b16 v[88:89], v15 offset:12288
  ds_read_b64_tr_b16 v[90:91], v15 offset:12544
  ds_read_b64_tr_b16 v[92:93], v15 offset:14336
  ds_read_b64_tr_b16 v[94:95], v15 offset:14592
  ds_read_b64_tr_b16 v[96:97], v15 offset:16384
  ds_read_b64_tr_b16 v[98:99], v15 offset:16640
  ds_read_b64_tr_b16 v[100:101], v15 offset:18432
  ds_read_b64_tr_b16 v[102:103], v15 offset:18688
  ds_read_b64_tr_b16 v[104:105], v15 offset:20480
  ds_read_b64_tr_b16 v[106:107], v15 offset:20736
  ds_read_b64_tr_b16 v[108:109], v15 offset:22528
  ds_read_b64_tr_b16 v[110:111], v15 offset:22784
  ds_read_b64_tr_b16 v[112:113], v15 offset:24576
  ds_read_b64_tr_b16 v[114:115], v15 offset:24832
  ds_read_b64_tr_b16 v[116:117], v15 offset:26624
  ds_read_b64_tr_b16 v[118:119], v15 offset:26880
  ds_read_b64_tr_b16 v[120:121], v15 offset:28672
  ds_read_b64_tr_b16 v[122:123], v15 offset:28928
  ds_read_b64_tr_b16 v[124:125], v15 offset:30720
  ds_read_b64_tr_b16 v[126:127], v15 offset:30976
  v_mov_b32 v224, -1
  v_mov_b32 v225, -1
  v_mov_b32 v226, -1
  v_mov_b32 v227, -1
  v_mov_b32 v228, -1
  v_mov_b32 v229, -1
  v_mov_b32 v230, -1
  v_mov_b32 v231, -1
  v_mov_b32 v232, -1
  v_mov_b32 v233, -1
  v_mov_b32 v234, -1
  v_mov_b32 v235, -1
  v_mov_b32 v236, -1
  v_mov_b32 v237, -1
  v_mov_b32 v238, -1
  v_mov_b32 v239, -1
  s_mov_b64 s[84:85], -1
  s_mov_b64 s[86:87], -1
  s_mov_b64 s[88:89], -1
  s_mov_b64 s[90:91], -1
L_py:
  s_mov_b64 exec, s[84:85]
  global_load_dwordx4 v[224:227], v16, s[46:47] offset:-4096 sc1
  s_mov_b64 exec, s[86:87]
  global_load_dwordx4 v[228:231], v16, s[46:47] offset:0 sc1
  s_mov_b64 exec, s[88:89]
  global_load_dwordx4 v[232:235], v22, s[46:47] offset:-4096 sc1
  s_mov_b64 exec, s[90:91]
  global_load_dwordx4 v[236:239], v22, s[46:47] offset:0 sc1
  s_mov_b64 exec, -1
  s_sub_u32 s60, s60, 1
  s_cbranch_scc1 L_abort
  s_waitcnt vmcnt(8)
  v_max3_u32 v36, v224, v225, v226
  v_max_u32 v36, v36, v227
  v_cmp_eq_u32 s[84:85], -1, v36
  v_max3_u32 v37, v228, v229, v230
  v_max_u32 v37, v37, v231
  v_cmp_eq_u32 s[86:87], -1, v37
  v_max3_u32 v36, v232, v233, v234
  v_max_u32 v36, v36, v235
  v_cmp_eq_u32 s[88:89], -1, v36
  v_max3_u32 v37, v236, v237, v238
  v_max_u32 v37, v37, v239
  v_cmp_eq_u32 s[90:91], -1, v37
  s_or_b64 vcc, s[84:85], s[86:87]
  s_or_b64 vcc, vcc, s[88:89]
  s_or_b64 vcc, vcc, s[90:91]
  s_cbranch_scc1 L_py
  v_pk_add_f32 v[28:29], v[224:225], v[228:229]
  v_pk_add_f32 v[30:31], v[226:227], v[230:231]
  v_pk_add_f32 v[32:33], v[232:233], v[236:237]
  v_pk_add_f32 v[34:35], v[234:235], v[238:239]
  v_pk_add_f32 v[28:29], v[28:29], v[32:33]
  v_pk_add_f32 v[30:31], v[30:31], v[34:35]
  s_nop 1
  v_permlane32_swap_b32 v28, v30
  v_permlane32_swap_b32 v29, v31
  s_nop 0
  v_pk_add_f32 v[28:29], v[28:29], v[30:31]
  v_cvt_pk_bf16_f32 v28, v28, v29
  v_and_b32 v29, s61, v28
  v_lshlrev_b32 v28, 16, v28
  v_pk_add_f32 v[28:29], v[28:29], v[48:49]
  v_cvt_pk_bf16_f32 v28, v28, v29
  ds_write_b32 v6, v28 offset:1024
  v_mov_b32 v40, 0
  v_mov_b32 v41, 0
  s_waitcnt lgkmcnt(0)
  s_barrier
  ds_read_b128 v[28:31], v5 offset:1024
  ds_read_b128 v[128:131], v17 offset:1024
  ds_read_b128 v[132:135], v17 offset:1088
  ds_read_b128 v[136:139], v17 offset:1152
  ds_read_b128 v[140:143], v17 offset:1216
  ds_read_b128 v[144:147], v17 offset:1280
  s_waitcnt lgkmcnt(4)
  v_mfma_f32_16x16x32_bf16 v[44:47], v[128:131], v[64:67], 0
  ds_read_b128 v[148:151], v17 offset:1344
  v_dot2c_f32_bf16 v40, v28, v52
  v_dot2c_f32_bf16 v41, v28, v28
  v_dot2c_f32_bf16 v40, v29, v52
  s_waitcnt lgkmcnt(4)
  v_mfma_f32_16x16x32_bf16 v[44:47], v[132:135], v[68:71], v[44:47]
  ds_read_b128 v[152:155], v17 offset:1408
  v_dot2c_f32_bf16 v41, v29, v29
  v_dot2c_f32_bf16 v40, v30, v52
  v_dot2c_f32_bf16 v41, v30, v30
  s_waitcnt lgkmcnt(4)
  v_mfma_f32_16x16x32_bf16 v[44:47], v[136:139], v[72:75], v[44:47]
  ds_read_b128 v[156:159], v17 offset:1472
  v_dot2c_f32_bf16 v40, v31, v52
  v_dot2c_f32_bf16 v41, v31, v31
  s_waitcnt lgkmcnt(4)
  v_mfma_f32_16x16x32_bf16 v[44:47], v[140:143], v[76:79], v[44:47]
  ds_read_b128 v[160:163], v17 offset:1536
  v_permlane32_swap_b32 v40, v41
  s_waitcnt lgkmcnt(4)
  v_mfma_f32_16x16x32_bf16 v[44:47], v[144:147], v[80:83], v[44:47]
  ds_read_b128 v[164:167], v17 offset:1600
  v_add_f32 v40, v40, v41
  v_mov_b32 v41, v40
  s_waitcnt lgkmcnt(4)
  v_mfma_f32_16x16x32_bf16 v[44:47], v[148:151], v[84:87], v[44:47]
  ds_read_b128 v[168:171], v17 offset:1664
  v_permlane16_swap_b32 v41, v40
  s_waitcnt lgkmcnt(4)
  v_mfma_f32_16x16x32_bf16 v[44:47], v[152:155], v[88:91], v[44:47]
  ds_read_b128 v[172:175], v17 offset:1728
  v_add_f32 v40, v40, v41
  s_waitcnt lgkmcnt(4)
  v_mfma_f32_16x16x32_bf16 v[44:47], v[156:159], v[92:95], v[44:47]
  ds_read_b128 v[176:179], v17 offset:1792
  v_add_f32_dpp v40, v40, v40 row_ror:1 row_mask:0xf bank_mask:0xf
  s_waitcnt lgkmcnt(4)
  v_mfma_f32_16x16x32_bf16 v[44:47], v[160:163], v[96:99], v[44:47]
  ds_read_b128 v[180:183], v17 offset:1856
  v_add_f32_dpp v40, v40, v40 row_ror:2 row_mask:0xf bank_mask:0xf
  s_waitcnt lgkmcnt(4)
  v_mfma_f32_16x16x32_bf16 v[44:47], v[164:167], v[100:103], v[44:47]
  ds_read_b128 v[184:187], v17 offset:1920
  v_add_f32_dpp v40, v40, v40 row_ror:4 row_mask:0xf bank_mask:0xf
  s_waitcnt lgkmcnt(4)
  v_mfma_f32_16x16x32_bf16 v[44:47], v[168:171], v[104:107], v[44:47]
  ds_read_b128 v[188:191], v17 offset:1984
  v_add_f32_dpp v40, v40, v40 row_ror:8 row_mask:0xf bank_mask:0xf
  v_mul_f32 v40, 0x3b000000, v40
  s_waitcnt lgkmcnt(4)
  v_mfma_f32_16x16x32_bf16 v[44:47], v[172:175], v[108:111], v[44:47]
  v_readlane_b32 s6, v40, 32
  v_readlane_b32 s7, v40, 0
  s_waitcnt lgkmcnt(3)
  v_mfma_f32_16x16x32_bf16 v[44:47], v[176:179], v[112:115], v[44:47]
  v_mov_b32 v40, s7
  v_fma_f32 v41, -v40, v40, s6
  v_max_f32 v41, 0, v41
  s_waitcnt lgkmcnt(2)
  v_mfma_f32_16x16x32_bf16 v[44:47], v[180:183], v[116:119], v[44:47]
  v_cvt_pk_bf16_f32 v41, v41, v41
  v_and_b32 v41, s61, v41
  v_add_f32 v41, 0x3727c5ac, v41
  s_waitcnt lgkmcnt(1)
  v_mfma_f32_16x16x32_bf16 v[44:47], v[184:187], v[120:123], v[44:47]
  v_cvt_pk_bf16_f32 v41, v41, v41
  v_and_b32 v41, s61, v41
  v_sqrt_f32 v41, v41
  s_waitcnt lgkmcnt(0)
  v_mfma_f32_16x16x32_bf16 v[44:47], v[188:191], v[124:127], v[44:47]
  v_cvt_pk_bf16_f32 v41, v41, v41
  v_and_b32 v41, s61, v41
  v_rcp_f32 v41, v41
  v_cvt_pk_bf16_f32 v40, v40, v40
  v_and_b32 v40, s61, v40
  s_nop 2
  v_fma_f32 v44, -v40, v45, v44
  v_mul_f32 v44, v44, v41
  v_cvt_pk_bf16_f32 v44, v44, v44
  v_and_b32 v44, s61, v44
  v_mul_f32 v45, s59, v44
  v_exp_f32 v45, -v45
  v_mov_b32_dpp v46, v44 row_shl:8 row_mask:0xf bank_mask:0xf
  v_add_f32 v45, 1.0, v45
  v_rcp_f32 v45, v45
  s_mov_b32 exec_lo, 0x00ff00ff
  s_mov_b32 exec_hi, 0x00ff00ff
  v_mul_f32 v45, v44, v45
  v_cvt_pk_bf16_f32 v45, v45, v45
  v_and_b32 v45, s61, v45
  v_mul_f32 v45, v45, v46
  v_cvt_pk_bf16_f32 v45, v45, v45
  ds_write_b16 v20, v45
  ds_write_b16 v18, v45
  s_mov_b64 exec, -1
  s_waitcnt lgkmcnt(0)
  s_barrier
  ds_read_b128 v[160:163], v19 offset:0
  ds_read_b128 v[164:167], v19 offset:1024
  ds_read_b128 v[168:171], v19 offset:2048
  ds_read_b128 v[172:175], v19 offset:3072
  ds_read_b128 v[176:179], v19 offset:4096
  s_waitcnt vmcnt(0)
  s_waitcnt lgkmcnt(4)
  v_mfma_f32_16x16x32_bf16 v[40:43], v[160:163], v[192:195], 0
  ds_read_b128 v[180:183], v19 offset:5120
  s_waitcnt lgkmcnt(4)
  v_mfma_f32_16x16x32_bf16 v[40:43], v[164:167], v[196:199], v[40:43]
  ds_read_b128 v[184:187], v19 offset:6144
  s_waitcnt lgkmcnt(4)
  v_mfma_f32_16x16x32_bf16 v[40:43], v[168:171], v[200:203], v[40:43]
  ds_read_b128 v[188:191], v19 offset:7168
  s_waitcnt lgkmcnt(4)
  v_mfma_f32_16x16x32_bf16 v[40:43], v[172:175], v[204:207], v[40:43]
  s_waitcnt lgkmcnt(3)
  v_mfma_f32_16x16x32_bf16 v[40:43], v[176:179], v[208:211], v[40:43]
  s_waitcnt lgkmcnt(2)
  v_mfma_f32_16x16x32_bf16 v[40:43], v[180:183], v[212:215], v[40:43]
  s_waitcnt lgkmcnt(1)
  v_mfma_f32_16x16x32_bf16 v[40:43], v[184:187], v[216:219], v[40:43]
  s_waitcnt lgkmcnt(0)
  v_mfma_f32_16x16x32_bf16 v[40:43], v[188:191], v[220:223], v[40:43]
  s_mov_b32 exec_hi, 0
  s_nop 6
  v_min_u32 v40, -2, v40
  v_min_u32 v41, -2, v41
  v_min_u32 v42, -2, v42
  v_min_u32 v43, -2, v43
  global_store_dwordx4 v21, v[40:43], s[44:45] sc1
  global_store_dwordx4 v21, v[40:43], s[46:47] sc1
  s_or_b32 s6, s2, s3
  s_cbranch_scc1 L_Tfin
  s_mov_b64 exec, 1
  v_mov_b32 v46, 16384
  v_mov_b32 v47, s63
  global_store_dword v46, v47, s[38:39] sc1
  s_branch L_Tfin
L_R:
  s_cmp_lg_u32 s3, 3
  s_cbranch_scc1 L_rcal_j
  s_call_b64 s[92:93], L_scjob
L_rcal_j:
  s_add_u32 s44, s38, 0x2000
  s_addc_u32 s45, s39, 0
  s_lshl_b32 s6, s2, 2
  s_add_u32 s6, s6, s3
  s_lshr_b32 s7, s6, 6
  s_lshl_b32 s7, s7, 14
  s_and_b32 s6, s6, 63
  s_lshl_b32 s6, s6, 7
  s_add_u32 s6, s6, s7
  s_add_u32 s6, s6, 1835008
  s_mov_b32 s56, -1
  s_mov_b32 s57, -1
  s_memtime s[12:13]
  v_mov_b32 v10, 264
L_rcal:
  s_memtime s[8:9]
  s_waitcnt lgkmcnt(0)
  s_load_dword s7, s[38:39], s6 glc
  s_waitcnt lgkmcnt(0)
  s_memtime s[10:11]
  s_waitcnt lgkmcnt(0)
  s_sub_u32 s7, s10, s8
  s_min_u32 s56, s56, s7
  s_memtime s[8:9]
  s_waitcnt lgkmcnt(0)
  s_load_dword s7, s[44:45], s6 glc
  s_waitcnt lgkmcnt(0)
  s_memtime s[10:11]
  s_waitcnt lgkmcnt(0)
  s_sub_u32 s7, s10, s8
  s_min_u32 s57, s57, s7
  ds_read_b32 v28, v10
  s_min_u32 s7, s56, s57
  s_cmp_lt_u32 s7, 540
  s_cbranch_scc1 L_rcal_c
  s_waitcnt lgkmcnt(0)
  v_readfirstlane_b32 s14, v28
  s_cmp_lg_u32 s14, 0
  s_cbranch_scc1 L_rcal_s
  s_sub_u32 s7, s10, s12
  s_cmp_lt_u32 s7, 30000
  s_cbranch_scc1 L_rcal
L_rcal_c:
  s_cmp_lt_u32 s57, s56
  s_cselect_b32 s14, 2, 1
  v_mov_b32 v29, s14
  ds_write_b32 v10, v29
L_rcal_s:
  s_cmp_eq_u32 s14, 2
  s_cselect_b32 s6, 0x2000, 0
L_rcal_d:
  s_waitcnt lgkmcnt(0)
  s_add_u32 s46, s38, s6
  s_addc_u32 s47, s39, 0
  s_xor_b32 s6, s6, 0x2000
  s_add_u32 s44, s38, s6
  s_addc_u32 s45, s39, 0
  s_cmp_lg_u32 s3, 3
  s_cbranch_scc1 L_rag
  s_call_b64 s[92:93], L_agent
L_rag:
  s_cmp_lg_u32 s3, 0
  s_cbranch_scc1 L_end
  s_lshl_b32 s49, s5, 2
  s_and_b32 s6, s48, 3
  s_add_u32 s49, s49, s6
  s_lshr_b32 s6, s49, 3
  s_lshl_b32 s6, s6, 7
  s_and_b32 s7, s49, 3
  s_lshl_b32 s7, s7, 5
  s_add_u32 s6, s6, s7
  s_and_b32 s7, s49, 4
  s_add_u32 s50, s6, s7
  v_lshl_add_u32 v15, v12, 3, s50
  v_add_u32 v21, v15, v3
  v_lshlrev_b32 v21, 1, v21
  global_load_ushort v8, v21, s[16:17]
  v_lshrrev_b32 v13, 2, v0
  v_and_b32 v14, 7, v13
  v_lshrrev_b32 v16, 4, v15
  v_lshlrev_b32 v16, 7, v16
  v_and_b32 v15, 15, v15
  v_lshl_add_u32 v16, v15, 2, v16
  v_and_b32 v15, 1, v14
  v_lshl_add_u32 v16, v15, 12, v16
  v_lshrrev_b32 v15, 1, v14
  v_lshl_add_u32 v16, v15, 14, v16
  v_add_u32 v16, 65536, v16
  s_lshl_b32 s6, s49, 6
  s_add_u32 s6, s6, 1572864
  v_and_b32 v15, 3, v13
  v_lshlrev_b32 v15, 11, v15
  v_lshl_add_u32 v15, v12, 4, v15
  v_add_u32 v15, s6, v15
  v_lshl_add_u32 v18, v3, 14, v15
  v_add_u32 v19, 65536, v18
  v_add_u32 v20, 131072, v18
  v_and_b32 v22, 1, v3
  v_lshl_add_u32 v22, v22, 14, v15
  v_add_u32 v22, 196608, v22
  v_and_b32 v10, 7, v0
  s_lshr_b32 s6, s50, 6
  s_add_u32 s6, s6, 16
  v_mov_b32 v11, s6
  v_cmp_eq_u32 vcc, 7, v10
  s_nop 1
  v_cndmask_b32 v10, v10, v11, vcc
  v_lshrrev_b32 v11, 3, v0
  v_lshlrev_b32 v28, 2, v11
  v_sub_u32 v10, v10, v28
  v_and_b32 v10, 31, v10
  v_lshl_add_u32 v10, v10, 3, v11
  s_getpc_b64 s[6:7]
L_pcr:
  s_add_u32 s6, s6, L_ry-L_pcr
  s_addc_u32 s7, s7, 0
  v_lshlrev_b32 v28, 7, v0
  s_mov_b64 exec, 63
  global_load_dword v250, v28, s[6:7]
  s_mov_b64 exec, -1
  v_lshlrev_b32 v10, 7, v10
  v_add_u32 v10, 196608, v10
L_rclr:
  global_load_dword v28, v10, s[38:39] sc1
  s_sub_u32 s60, s60, 1
  s_cbranch_scc1 L_abort
  s_waitcnt vmcnt(0)
  v_cmp_ne_u32 vcc, s63, v28
  s_cbranch_vccnz L_rclr
  v_lshlrev_b32 v8, 16, v8
  v_mov_b32 v40, 0
  v_mov_b32 v41, 0
  v_mov_b32 v42, 0
  v_mov_b32 v43, 0
  s_barrier
  s_mov_b32 exec_hi, 0
L_ry:
  s_sleep 2
  global_load_dwordx4 v[40:43], v16, s[46:47] sc1
  s_sub_u32 s60, s60, 1
  s_cbranch_scc1 L_abort
  s_waitcnt vmcnt(0)
  v_max3_u32 v36, v40, v41, v42
  v_max_u32 v36, v36, v43
  v_cmp_eq_u32 vcc, -1, v36
  s_and_b64 exec, vcc, vcc
  s_cbranch_scc1 L_ry
  s_mov_b64 exec, -1
  s_nop 0
  v_permlane32_swap_b32 v40, v42
  v_permlane32_swap_b32 v41, v43
  s_nop 0
  v_pk_add_f32 v[40:41], v[40:41], v[42:43]
  s_nop 1
  v_permlane16_swap_b32 v40, v41
  s_nop 0
  v_add_f32 v40, v40, v41
  s_nop 1
  v_add_f32_dpp v40, v40, v40 row_ror:4 row_mask:0xf bank_mask:0xf
  s_nop 1
  v_add_f32_dpp v40, v40, v40 row_ror:8 row_mask:0xf bank_mask:0xf
  v_cvt_pk_bf16_f32 v40, v40, v40
  v_and_b32 v40, s61, v40
  v_add_f32 v8, v8, v40
  v_cvt_pk_bf16_f32 v8, v8, v8
  v_and_b32 v8, s61, v8
  v_mov_b32 v128, -1
  v_mov_b32 v129, -1
  v_mov_b32 v130, -1
  v_mov_b32 v131, -1
  v_mov_b32 v132, -1
  v_mov_b32 v133, -1
  v_mov_b32 v134, -1
  v_mov_b32 v135, -1
  v_mov_b32 v136, -1
  v_mov_b32 v137, -1
  v_mov_b32 v138, -1
  v_mov_b32 v139, -1
  v_mov_b32 v140, -1
  v_mov_b32 v141, -1
  v_mov_b32 v142, -1
  v_mov_b32 v143, -1
  s_mov_b64 s[84:85], -1
  s_mov_b64 s[86:87], -1
  s_mov_b64 s[88:89], -1
  s_mov_b64 s[90:91], -1
L_rz:
  s_mov_b64 exec, s[84:85]
  global_load_dwordx4 v[128:131], v18, s[46:47] sc1
  s_mov_b64 exec, s[86:87]
  global_load_dwordx4 v[132:135], v19, s[46:47] sc1
  s_mov_b64 exec, s[88:89]
  global_load_dwordx4 v[136:139], v20, s[46:47] sc1
  s_mov_b64 exec, s[90:91]
  global_load_dwordx4 v[140:143], v22, s[46:47] sc1
  s_mov_b64 exec, -1
  s_sub_u32 s60, s60, 1
  s_cbranch_scc1 L_abort
  s_waitcnt vmcnt(8)
  v_max3_u32 v36, v128, v129, v130
  v_max_u32 v36, v36, v131
  v_cmp_eq_u32 s[84:85], -1, v36
  v_max3_u32 v37, v132, v133, v134
  v_max_u32 v37, v37, v135
  v_cmp_eq_u32 s[86:87], -1, v37
  v_max3_u32 v36, v136, v137, v138
  v_max_u32 v36, v36, v139
  v_cmp_eq_u32 s[88:89], -1, v36
  v_max3_u32 v37, v140, v141, v142
  v_max_u32 v37, v37, v143
  v_cmp_eq_u32 s[90:91], -1, v37
  s_or_b64 vcc, s[84:85], s[86:87]
  s_or_b64 vcc, vcc, s[88:89]
  s_or_b64 vcc, vcc, s[90:91]
  s_cbranch_scc1 L_rz
  v_pk_add_f32 v[40:41], v[128:129], v[132:133]
  v_pk_add_f32 v[42:43], v[130:131], v[134:135]
  v_pk_add_f32 v[40:41], v[40:41], v[136:137]
  v_pk_add_f32 v[42:43], v[42:43], v[138:139]
  s_mov_b32 exec_hi, 0
  v_pk_add_f32 v[40:41], v[40:41], v[140:141]
  v_pk_add_f32 v[42:43], v[42:43], v[142:143]
  s_mov_b32 exec_hi, -1
  s_nop 0
  v_permlane32_swap_b32 v40, v42
  v_permlane32_swap_b32 v41, v43
  s_nop 0
  v_pk_add_f32 v[40:41], v[40:41], v[42:43]
  s_nop 1
  v_permlane16_swap_b32 v40, v41
  s_nop 0
  v_add_f32 v40, v40, v41
  s_nop 1
  v_add_f32_dpp v40, v40, v40 row_ror:4 row_mask:0xf bank_mask:0xf
  s_nop 1
  v_add_f32_dpp v40, v40, v40 row_ror:8 row_mask:0xf bank_mask:0xf
  s_mov_b32 exec_lo, 0x000f000f
  s_mov_b32 exec_hi, 0x000f000f
  v_cvt_pk_bf16_f32 v40, v40, v40
  v_and_b32 v40, s61, v40
  v_add_f32 v8, v8, v40
  v_cvt_pk_bf16_f32 v8, v8, v8
  global_store_short v21, v8, s[34:35]
  s_endpgm
L_norole:
  s_cmp_lg_u32 s3, 3
  s_cbranch_scc1 L_Tfin
  s_call_b64 s[92:93], L_scjob
  s_call_b64 s[92:93], L_agent
  s_endpgm
L_agent:
  s_lshl_b32 s6, s4, 8
  s_add_u32 s8, s38, s6
  s_addc_u32 s9, s39, 0
  v_mov_b32 v10, 288
  v_mov_b32 v30, 512
  s_mov_b32 s10, 1
L_ag1:
  s_sleep 1
  ds_read_b32 v28, v10
  s_sub_u32 s60, s60, 1
  s_cbranch_scc1 L_abort
  s_waitcnt lgkmcnt(0)
  v_cmp_gt_u32 vcc, s10, v28
  s_cbranch_vccnz L_ag1
  s_mov_b32 s11, 1
  s_atomic_add s11, s[8:9], 0 glc
  s_add_u32 s10, s10, 4
  s_waitcnt lgkmcnt(0)
  s_add_u32 s11, s11, 1
  v_mov_b32 v29, s11
  ds_write_b32 v30, v29
  v_add_u32 v30, 4, v30
  s_cmp_le_u32 s11, 16
  s_cbranch_scc1 L_ag1
  s_waitcnt lgkmcnt(0)
  s_setpc_b64 s[92:93]
L_scjob:
  v_mov_b32 v10, 268
L_sc1:
  s_sleep 2
  ds_read_b32 v28, v10
  s_sub_u32 s60, s60, 1
  s_cbranch_scc1 L_abort
  s_waitcnt lgkmcnt(0)
  v_cmp_ne_u32 vcc, 4, v28
  s_cbranch_vccnz L_sc1
  v_add_u32 v30, 77312, v5
  v_lshrrev_b32 v31, 4, v0
  v_lshlrev_b32 v31, 15, v31
  v_and_b32 v29, 15, v0
  v_lshl_add_u32 v31, v29, 4, v31
  s_and_b32 s6, s2, 127
  s_lshl_b32 s6, s6, 8
  s_lshr_b32 s7, s2, 7
  s_lshl_b32 s7, s7, 18
  s_add_u32 s6, s6, s7
  s_add_u32 s6, s6, 2097152
  v_add_u32 v31, s6, v31
  ds_read_b128 v[32:35], v30 offset:0
  v_add_u32 v29, 131072, v31
  s_waitcnt lgkmcnt(0)
  s_mov_b32 exec_lo, 0xffffffff
  s_mov_b32 exec_hi, 0x0
  global_store_dwordx4 v31, v[32:35], s[38:39] sc1
  s_mov_b64 exec, -1
  s_waitcnt vmcnt(0)
  v_mov_b32 v10, 256
L_sc2:
  s_sleep 2
  ds_read_b32 v28, v10
  s_sub_u32 s60, s60, 1
  s_cbranch_scc1 L_abort
  s_waitcnt lgkmcnt(0)
  v_cmp_ne_u32 vcc, 4, v28
  s_cbranch_vccnz L_sc2
  v_mov_b32 v30, 272
  ds_read_b128 v[32:35], v30
  s_lshl_b32 s6, s2, 7
  s_add_u32 s6, s6, 131072
  v_mov_b32 v30, s6
  s_waitcnt lgkmcnt(0)
  v_max3_f32 v29, v32, v33, v34
  v_max_f32 v29, v29, v35
  v_max_f32 v29, 0xff7fffff, v29
  v_sub_f32 v32, v32, v29
  v_sub_f32 v33, v33, v29
  v_sub_f32 v34, v34, v29
  v_sub_f32 v35, v35, v29
  v_exp_f32 v32, v32
  v_exp_f32 v33, v33
  v_exp_f32 v34, v34
  v_exp_f32 v35, v35
  v_add_f32 v32, v32, v33
  v_add_f32 v34, v34, v35
  v_add_f32 v32, v32, v34
  v_log_f32 v32, v32
  v_mov_b32 v33, s63
  v_add_f32 v32, v32, v29
  s_mov_b64 exec, 1
  global_store_dwordx2 v30, v[32:33], s[38:39] sc1
  s_mov_b64 exec, -1
  s_setpc_b64 s[92:93]
L_abort:
L_end:
  s_endpgm
L_codeend:
.section .rodata,"a"
.p2align 6
.amdhsa_kernel sequential_preLN__mha_block_cached__swiglu_ffn__decode_kernel
  .amdhsa_next_free_vgpr 256
  .amdhsa_next_free_sgpr 102
  .amdhsa_accum_offset 256
  .amdhsa_group_segment_fixed_size 0
  .amdhsa_kernarg_size 96
  .amdhsa_user_sgpr_count 2
  .amdhsa_user_sgpr_kernarg_segment_ptr 1
  .amdhsa_system_sgpr_workgroup_id_x 1
  .amdhsa_float_denorm_mode_32 3
.end_amdhsa_kernel
```
